```python
import torch

def _softmax(x, axis=-1):
    return torch.softmax(x, dim=axis)
def _gelu(x):
    return torch.nn.functional.gelu(x, approximate="tanh")
def _silu(x):
    return torch.nn.functional.silu(x)
def _sigmoid(x):
    return torch.sigmoid(x)
def _layernorm(x, axis=-1, eps=1e-5):
    m = x.mean(dim=axis, keepdim=True)
    v = x.var(dim=axis, keepdim=True, unbiased=False)
    return (x - m) / torch.sqrt(v + eps)
def _scatter_add(tgt, idx, src, axis=0):
    return tgt.clone().index_add_(axis, idx, src)
def _segment_sum(src, seg, n):
    out = torch.zeros((n,) + src.shape[1:], dtype=src.dtype)
    return out.index_add_(0, seg, src)
def _pad(x, pw):
    flat = tuple(v for pair in reversed(pw) for v in pair)
    return torch.nn.functional.pad(x, flat)

kernel_name = 'gated_mix__mha_block__moe_arch_mod__prompt'

def setup_inputs():

    _w = (lambda a: (lambda t: t.to(torch.bfloat16) if t.is_floating_point() else t)(torch.as_tensor(a)))
    def _A_setup():
        B, S, D, H = 1, 2048, 512, 32
        return {
            "x": _w((lambda *s: torch.randn(*s, dtype=torch.bfloat16) * 0.05)(B, S, D)),
            "wqkv": _w((lambda *s: torch.randn(*s, dtype=torch.bfloat16) * 0.8)(D, 3 * D)),
            "wo": _w((lambda *s: torch.randn(*s, dtype=torch.bfloat16) * 0.1)(D, D)),
        }
    _A_in = _A_setup()

    def _B_setup():
        B, S, D, F, C = 1, 2048, 512, 1376, 1
        return {
            "x": _w((lambda *s: torch.randn(*s, dtype=torch.bfloat16) * 0.05)(B, S, D)),
            "w_r": _w((lambda *s: torch.randn(*s, dtype=torch.bfloat16) * 3.2)(D)),
            "w_gate": _w((lambda *s: torch.randn(*s, dtype=torch.bfloat16) * 0.2)(D, F)),
            "w_up": _w((lambda *s: torch.randn(*s, dtype=torch.bfloat16) * 0.2)(D, F)),
            "w_down": _w((lambda *s: torch.randn(*s, dtype=torch.bfloat16) * 0.2)(F, D)),
        }
    _B_in = _B_setup()

    return {
        "A_x": _A_in["x"],
        "A_wqkv": _A_in["wqkv"],
        "A_wo": _A_in["wo"],
        "B_x": _B_in["x"],
        "B_w_r": _B_in["w_r"],
        "B_w_gate": _B_in["w_gate"],
        "B_w_up": _B_in["w_up"],
        "B_w_down": _B_in["w_down"],
        "gate_w": _w((lambda *s: torch.randn(*s, dtype=torch.bfloat16) * 0.05)(512) * 16.0),
    }

def reference(A_x, A_wqkv, A_wo, B_x, B_w_r, B_w_gate, B_w_up, B_w_down, gate_w):
    def _A_ref(x, wqkv, wo):
        B, S, D = x.shape
        H = 32
        Dh = D // H
        qkv = (lambda x, *d: x.permute(*d))((x @ wqkv).reshape(B, S, 3, H, Dh), 2, 0, 3, 1, 4)
        q, k, v = qkv[0], qkv[1], qkv[2]
        scores = torch.einsum("bhqd,bhkd->bhqk", q, k) * (Dh ** -0.5)
        p = _softmax(scores, axis=-1)
        o = torch.einsum("bhqk,bhkd->bhqd", p, v)
        return (lambda x, *d: x.permute(*d))(o, 0, 2, 1, 3).reshape(B, S, D) @ wo

    def _B_ref(x, w_r, w_gate, w_up, w_down):
        B, S, D = x.shape
        C = 1
        r = x @ w_r
        idx = torch.argsort(-r, axis=-1)[:, :C]
        idx_e = (lambda x, n, axis: torch.repeat_interleave(x, n, dim=axis))(idx.reshape(B, C, 1), D, axis=2)
        x_sel = (lambda x, i, axis: torch.take_along_dim(x, i, dim=axis))(x, idx_e, axis=1)
        g = _silu(x_sel @ w_gate)
        u = x_sel @ w_up
        y = (g * u) @ w_down
        r_sel = _sigmoid((lambda x, i, axis: torch.take_along_dim(x, i, dim=axis))(r, idx, axis=1))
        y = y * r_sel.reshape(B, C, 1)
        b_off = (torch.arange(B) * S).reshape(B, 1)
        flat_idx = (idx + b_off).reshape(B * C)
        zero = (x * 0.0).reshape(B * S, D)
        upd = _scatter_add(zero, flat_idx, y.reshape(B * C, D), axis=0)
        return x + upd.reshape(B, S, D)

    x = A_x
    g = _sigmoid((x * gate_w).sum(-1, keepdims=True))
    a = _A_ref(x, A_wqkv, A_wo)
    b = _B_ref(x, B_w_r, B_w_gate, B_w_up, B_w_down)
    return g * a + (1 - g) * b
```

```asm
; @launch grid=(256,1,1) block=(576,1,1) lds=163840
.amdgcn_target "amdgcn-amd-amdhsa--gfx950"
.text
.globl gated_mix__mha_block__moe_arch_mod__prompt_kernel
.p2align 8
.type gated_mix__mha_block__moe_arch_mod__prompt_kernel,@function
gated_mix__mha_block__moe_arch_mod__prompt_kernel:
    s_cmp_ge_u32 s2, 256
    s_cbranch_scc1 L_end
    s_load_dwordx16 s[36:51], s[0:1], 0
    s_load_dwordx8 s[52:59], s[0:1], 64
    s_getpc_b64 s[62:63]
L_text0:
    v_lshrrev_b32 v2, 6, v0
    v_lshlrev_b32 v3, 5, v0
    v_readfirstlane_b32 s20, v2
    v_min_u32 v3, L_end-L_text0, v3
    s_lshr_b32 s29, s2, 3
    s_xor_b32 s28, s29, s20
    s_and_b32 s28, s28, 0
    s_cbranch_scc1 L_nopf
    global_load_dword v159, v3, s[62:63]
L_nopf:
    v_and_b32 v1, 63, v0
    s_and_b32 s28, s2, 7
    s_and_b32 s21, s28, 1
    s_lshl_b32 s21, s21, 2
    s_and_b32 s30, s29, 3
    s_add_u32 s21, s21, s30
    s_lshr_b32 s22, s28, 1
    s_lshl_b32 s22, s22, 3
    s_lshr_b32 s31, s29, 2
    s_add_u32 s22, s22, s31
    s_lshl_b32 s23, s30, 1
    s_add_u32 s23, s23, s31
    s_lshl_b32 s68, s28, 2
    s_add_u32 s68, s68, s30
    s_mov_b32 s69, s31
    v_lshlrev_b32 v15, 4, v1
    v_lshrrev_b32 v2, 3, v1
    v_and_b32 v3, 7, v1
    v_lshrrev_b32 v4, 4, v1
    v_xor_b32 v5, v3, v4
    v_lshlrev_b32 v5, 4, v5
    v_lshl_add_u32 v10, v2, 10, v5
    v_xor_b32 v11, 64, v10
    v_add_u32 v11, 7168, v11
    v_and_b32 v4, 1, v4
    v_mul_u32_u24 v6, 3072, v2
    v_lshlrev_b32 v7, 2, v4
    v_xor_b32 v7, v3, v7
    v_lshl_add_u32 v12, v7, 4, v6
    s_lshl_b32 s25, s22, 16
    s_lshl_b32 s26, s20, 14
    s_add_u32 s25, s25, s26
    s_mul_i32 s26, s20, 49152
    s_lshl_b32 s27, s21, 7
    s_add_u32 s26, s26, s27
    s_lshl_b32 s27, s20, 11
    s_lshl_b32 s28, s20, 12
    s_mov_b32 s24, 0
    s_mov_b32 s6, 0x200000
    s_mov_b32 s7, 0x20000
    s_mov_b32 s18, 0x180000
    s_mov_b32 s19, 0x20000
    s_waitcnt lgkmcnt(0)
    s_mov_b64 s[4:5], s[36:37]
    s_mov_b64 s[16:17], s[38:39]
    s_cmp_ge_u32 s20, 4
    s_cbranch_scc1 L_notprod
L_pi:
    s_add_u32 s30, s23, s24
    s_and_b32 s30, s30, 7
    s_lshl_b32 s31, s30, 7
    s_add_u32 s31, s31, s25
    s_mul_i32 s32, s30, 196608
    s_mov_b32 m0, s27
    s_add_u32 s32, s32, s26
    buffer_load_dwordx4 v10, s[4:7], s31 offen lds
    buffer_load_dwordx4 v11, s[4:7], s31 offen offset:1024 lds
    s_add_u32 s33, s32, 23552
    s_add_u32 m0, s28, 65536
    s_add_u32 s32, s32, 1024
    buffer_load_dwordx4 v12, s[16:19], s32 offen lds
    buffer_load_dwordx4 v12, s[16:19], s32 offen offset:1024 lds
    buffer_load_dwordx4 v12, s[16:19], s33 offen offset:2048 lds
    buffer_load_dwordx4 v12, s[16:19], s33 offen offset:3072 lds
    s_add_u32 s27, s27, 8192
    s_add_u32 s28, s28, 16384
    s_and_b32 s28, s28, 0xffff
    s_add_u32 s24, s24, 1
    s_and_b32 s30, s24, 5
    s_cmp_eq_u32 s30, 1
    s_cbranch_scc1 L_pi
    s_cmp_lg_u32 s24, 2
    s_cbranch_scc1 L_pb
    s_waitcnt vmcnt(6)
L_pb:
    s_waitcnt vmcnt(12)
    s_barrier
    s_cmp_lt_u32 s24, 8
    s_cbranch_scc1 L_pi
L_pq:
    s_add_u32 s30, s23, s24
    s_and_b32 s30, s30, 7
    s_mul_i32 s32, s30, 196608
    s_add_u32 s32, s32, s26
    s_mov_b32 m0, s27
    s_add_u32 s33, s32, 23552
    buffer_load_dwordx4 v12, s[16:19], s32 offen lds
    buffer_load_dwordx4 v12, s[16:19], s33 offen offset:1024 lds
    s_add_u32 s27, s27, 8192
    s_add_u32 s24, s24, 1
    s_cmp_eq_u32 s24, 10
    s_cbranch_scc0 L_pq1
    s_waitcnt vmcnt(10)
    s_barrier
L_pq1:
    s_cmp_eq_u32 s24, 12
    s_cbranch_scc0 L_pq2
    s_waitcnt vmcnt(8)
    s_barrier
L_pq2:
    s_cmp_eq_u32 s24, 14
    s_cbranch_scc0 L_pq3
    s_waitcnt vmcnt(4)
    s_barrier
L_pq3:
    s_cmp_lt_u32 s24, 16
    s_cbranch_scc1 L_pq
    s_waitcnt vmcnt(4)
    s_barrier
    s_barrier
    s_waitcnt vmcnt(0)
    s_barrier
    s_branch L_setup
L_notprod:
    s_cmp_eq_u32 s20, 8
    s_cbranch_scc1 L_help
L_setup:
    s_mov_b32 s12, s58
    s_mov_b32 s13, s59
    s_mov_b32 s14, 0x920000
    s_mov_b32 s15, 0x20000
    s_and_b32 s40, s20, 3
    s_lshr_b32 s41, s20, 2
    s_lshl_b32 s42, s21, 2
    s_add_u32 s42, s42, s40
    s_mul_i32 s43, s42, 131072
    s_lshl_b32 s44, s41, 11
    s_add_u32 s43, s43, s44
    s_add_u32 s8, s58, s43
    s_addc_u32 s9, s59, 0
    s_mov_b32 s10, 0x20000
    s_mov_b32 s11, 0x20000
    s_mul_i32 s48, s20, 2304
    s_add_u32 s48, s48, 131072
    s_lshl_b32 s44, s40, 11
    s_lshl_b32 s46, s41, 10
    s_add_u32 s44, s44, s46
    s_add_u32 s44, s44, 149504
    v_add_u32 v151, s44, v15
    v_and_b32 v2, 0x33, v1
    v_bfe_u32 v3, v1, 2, 1
    v_lshl_or_b32 v2, v3, 3, v2
    v_bfe_u32 v3, v1, 3, 1
    v_lshl_or_b32 v2, v3, 2, v2
    v_lshlrev_b32 v149, 4, v2
    v_add_u32 v144, s48, v149
    v_and_b32 v2, 15, v1
    v_lshrrev_b32 v3, 5, v1
    v_lshl_add_u32 v2, v3, 4, v2
    v_lshlrev_b32 v148, 4, v2
    v_add_u32 v145, s48, v148
    v_and_b32 v5, 27, v1
    v_cmp_eq_u32 vcc, 16, v5
    v_mov_b32 v147, 0xdddddddd
    v_mov_b32 v5, 0x3f803f80
    s_mov_b32 s52, 0xffff
    s_mov_b32 s53, 0xffff
    v_cndmask_b32 v112, 0, v5, vcc
    v_mov_b32 v113, v112
    v_mov_b32 v114, v112
    v_mov_b32 v115, v112
    v_mov_b32 v116, v112
    v_mov_b32 v117, v112
    v_mov_b32 v118, v112
    v_mov_b32 v119, v112
    v_mov_b32 v120, v112
    v_mov_b32 v121, v112
    v_mov_b32 v122, v112
    v_mov_b32 v123, v112
    v_mov_b32 v124, v112
    v_mov_b32 v125, v112
    v_mov_b32 v126, v112
    v_mov_b32 v127, v112
    v_mov_b32 v128, v112
    v_mov_b32 v129, v112
    v_mov_b32 v130, v112
    v_mov_b32 v131, v112
    v_mov_b32 v132, v112
    v_mov_b32 v133, v112
    v_mov_b32 v134, v112
    v_mov_b32 v135, v112
    v_mov_b32 v136, v112
    v_mov_b32 v137, v112
    v_mov_b32 v138, v112
    v_mov_b32 v139, v112
    v_mov_b32 v140, v112
    v_mov_b32 v141, v112
    v_mov_b32 v142, v112
    v_mov_b32 v143, v112
    s_lshl_b32 s49, 1, s22
    s_mov_b32 s50, 8
    s_xor_b32 s46, s20, 4
    s_mul_i32 s46, s46, 2304
    s_add_u32 s46, s46, 131072
    v_add_u32 v152, s46, v149
    v_lshlrev_b32 v4, 2, v1
    v_add_u32 v153, s46, v4
    v_add_u32 v154, s48, v4
    s_lshl_b32 s45, s22, 16
    s_lshl_b32 s51, s42, 10
    s_add_u32 s51, s51, s45
    s_lshl_b32 s47, s41, 15
    s_add_u32 s51, s51, s47
    s_add_u32 s51, s51, 0x600000
    s_and_b32 s40, s20, 1
    s_bfe_u32 s41, s20, 0x10001
    s_lshl_b32 s45, s68, 16
    v_and_b32 v2, 31, v1
    s_lshl_b32 s43, s40, 5
    v_add_u32 v158, s43, v2
    v_lshlrev_b32 v2, 10, v158
    v_lshl_add_u32 v155, v3, 5, v2
    s_lshl_b32 s64, s41, 6
    s_lshl_b32 s44, s69, 7
    s_add_u32 s64, s64, s44
    s_add_u32 s64, s64, s45
    v_bfe_u32 v4, v1, 4, 1
    v_bfe_u32 v5, v1, 2, 2
    v_and_b32 v6, 1, v1
    v_bfe_u32 v7, v1, 3, 1
    v_xor_b32 v7, s41, v7
    v_lshlrev_b32 v2, 6, v7
    v_lshl_add_u32 v2, v6, 5, v2
    v_lshl_add_u32 v2, v4, 4, v2
    v_bfe_u32 v7, v1, 1, 1
    v_lshl_add_u32 v2, v7, 3, v2
    v_lshl_add_u32 v2, v5, 7, v2
    v_lshl_add_u32 v156, v3, 9, v2
    s_lshl_b32 s44, s40, 10
    s_add_u32 s44, s44, 65536
    v_add_u32 v157, s44, v15
    s_lshl_b32 s65, s41, 7
    s_and_b32 s44, s20, 3
    s_lshl_b32 s66, s44, 10
    s_add_u32 s66, s66, s45
    s_add_u32 s66, s66, 0x600000
    s_lshl_b32 s67, s44, 11
    s_add_u32 s67, s67, 65536
    s_mov_b64 vcc, 0
    s_cmp_ge_u32 s20, 4
    s_cbranch_scc1 L_comp
    buffer_load_dwordx4 v[160:163], v155, s[4:7], s64 offen
    buffer_load_dwordx4 v[164:167], v155, s[4:7], s64 offen offset:16
    s_branch L_b10
L_comp:
    s_and_b32 s24, s20, 1
    s_and_b32 s25, s20, 2
    v_and_b32 v2, 31, v1
    v_lshrrev_b32 v3, 5, v1
    v_lshlrev_b32 v4, 7, v2
    s_lshl_b32 s26, s24, 12
    v_add_u32 v4, s26, v4
    v_bfe_u32 v5, v2, 1, 3
    v_xor_b32 v5, v5, v3
    v_xor_b32 v6, 0, v5
    v_lshl_add_u32 v8, v6, 4, v4
    v_xor_b32 v6, 2, v5
    v_lshl_add_u32 v9, v6, 4, v4
    v_xor_b32 v6, 4, v5
    v_lshl_add_u32 v10, v6, 4, v4
    v_xor_b32 v6, 6, v5
    v_lshl_add_u32 v11, v6, 4, v4
    v_bfe_u32 v4, v1, 4, 1
    v_bfe_u32 v5, v1, 2, 2
    v_and_b32 v6, 3, v1
    v_bfe_u32 v7, v1, 3, 1
    v_lshlrev_b32 v7, 1, v7
    v_xor_b32 v7, v7, v4
    v_xor_b32 v7, s25, v7
    v_lshlrev_b32 v7, 5, v7
    v_lshl_add_u32 v7, v5, 7, v7
    v_lshl_add_u32 v7, v6, 3, v7
    v_add_u32 v7, 65536, v7
    v_lshl_add_u32 v12, v3, 11, v7
    v_lshl_add_u32 v13, v3, 10, v7
    s_lshl_b32 s26, s25, 11
    s_lshl_b32 s27, s24, 10
    s_add_u32 s26, s26, s27
    s_add_u32 s26, s26, 149504
    v_add_u32 v14, s26, v15
    s_lshl_b32 s26, s21, 2
    s_add_u32 s26, s26, s25
    s_mul_i32 s26, s26, 131072
    s_lshl_b32 s27, s22, 1
    s_add_u32 s27, s27, s24
    s_lshl_b32 s27, s27, 11
    s_add_u32 s26, s26, s27
    s_add_u32 s27, s26, 131072
    s_lshl_b32 s28, s24, 2
    s_add_u32 s28, s28, s25
    s_mul_i32 s28, s28, 2304
    s_add_u32 s28, s28, 131072
    v_and_b32 v7, 15, v1
    v_lshlrev_b32 v7, 4, v7
    v_lshl_add_u32 v7, v3, 8, v7
    v_mul_u32_u24 v5, 2304, v4
    v_add3_u32 v5, v5, v7, s28
    v_mul_u32_u24 v2, 131072, v4
    v_add_u32 v7, v7, v2
    v_add_u32 v2, s28, v15
    s_mov_b32 s30, 0x3eb8aa3b
    s_mov_b32 s31, 0x3eb8aa3b
    s_mov_b32 s29, 0x1ffff
    v_mov_b32 v6, 65536
    v_mov_b32 v88, 0
    v_mov_b32 v89, 0
    v_mov_b32 v90, 0
    v_mov_b32 v91, 0
    v_mov_b32 v92, 0
    v_mov_b32 v93, 0
    v_mov_b32 v94, 0
    v_mov_b32 v95, 0
    v_mov_b32 v96, 0
    v_mov_b32 v97, 0
    v_mov_b32 v98, 0
    v_mov_b32 v99, 0
    v_mov_b32 v100, 0
    v_mov_b32 v101, 0
    v_mov_b32 v102, 0
    v_mov_b32 v103, 0
    v_mov_b32 v104, 0
    v_mov_b32 v105, 0
    v_mov_b32 v106, 0
    v_mov_b32 v107, 0
    v_mov_b32 v108, 0
    v_mov_b32 v109, 0
    v_mov_b32 v110, 0
    v_mov_b32 v111, 0
    s_mov_b32 s24, 8
    s_nop 0
    v_mfma_f32_32x32x16_bf16 v[16:31], v[88:91], v[88:91], 0
    v_mfma_f32_32x32x16_bf16 v[32:47], v[88:91], v[88:91], 0
    v_mfma_f32_32x32x16_bf16 v[48:63], v[88:91], v[88:91], 0
L_cl:
    s_waitcnt lgkmcnt(0)
    s_barrier
    ds_read_b128 v[64:67], v8
    ds_read_b64_tr_b16 v[68:69], v12 offset:0
    ds_read_b64_tr_b16 v[70:71], v12 offset:512
    ds_read_b64_tr_b16 v[72:73], v12 offset:1024
    ds_read_b64_tr_b16 v[74:75], v12 offset:1536
    ds_read_b128 v[76:79], v9
    ds_read_b64_tr_b16 v[80:81], v12 offset:4096
    ds_read_b64_tr_b16 v[82:83], v12 offset:4608
    ds_read_b64_tr_b16 v[84:85], v12 offset:5120
    ds_read_b64_tr_b16 v[86:87], v12 offset:5632
    v_mfma_f32_32x32x16_bf16 v[16:31], v[92:95], v[88:91], v[16:31]
    v_mfma_f32_32x32x16_bf16 v[32:47], v[88:91], v[96:99], v[32:47]
    ds_read_b128 v[88:91], v10
    ds_read_b64_tr_b16 v[92:93], v12 offset:8192
    ds_read_b64_tr_b16 v[94:95], v12 offset:8704
    ds_read_b64_tr_b16 v[96:97], v12 offset:9216
    ds_read_b64_tr_b16 v[98:99], v12 offset:9728
    v_mfma_f32_32x32x16_bf16 v[16:31], v[104:107], v[100:103], v[16:31]
    v_mfma_f32_32x32x16_bf16 v[32:47], v[100:103], v[108:111], v[32:47]
    s_waitcnt lgkmcnt(10)
    ds_read_b128 v[100:103], v11
    ds_read_b64_tr_b16 v[104:105], v12 offset:12288
    ds_read_b64_tr_b16 v[106:107], v12 offset:12800
    ds_read_b64_tr_b16 v[108:109], v12 offset:13312
    ds_read_b64_tr_b16 v[110:111], v12 offset:13824
    v_mfma_f32_32x32x16_bf16 v[16:31], v[68:71], v[64:67], v[16:31]
    v_mfma_f32_32x32x16_bf16 v[32:47], v[64:67], v[72:75], v[32:47]
    v_add_u32 v8, 8192, v8
    v_add_u32 v9, 8192, v9
    v_add_u32 v10, 8192, v10
    v_add_u32 v11, 8192, v11
    v_add_u32 v12, 16384, v12
    v_and_or_b32 v12, v12, s29, v6
    s_sub_u32 s24, s24, 1
    s_waitcnt lgkmcnt(10)
    v_mfma_f32_32x32x16_bf16 v[16:31], v[80:83], v[76:79], v[16:31]
    v_mfma_f32_32x32x16_bf16 v[32:47], v[76:79], v[84:87], v[32:47]
    s_cmp_lg_u32 s24, 0
    s_cbranch_scc1 L_cl
    s_waitcnt lgkmcnt(5)
    v_mfma_f32_32x32x16_bf16 v[16:31], v[92:95], v[88:91], v[16:31]
    v_mfma_f32_32x32x16_bf16 v[32:47], v[88:91], v[96:99], v[32:47]
    s_waitcnt lgkmcnt(0)
    v_mfma_f32_32x32x16_bf16 v[16:31], v[104:107], v[100:103], v[16:31]
    v_mfma_f32_32x32x16_bf16 v[32:47], v[100:103], v[108:111], v[32:47]
    v_subrev_u32 v8, 0x10000, v8
    v_subrev_u32 v9, 0x10000, v9
    v_subrev_u32 v10, 0x10000, v10
    v_subrev_u32 v11, 0x10000, v11
    s_nop 6
    v_cvt_pk_bf16_f32 v64, v16, v17
    v_cvt_pk_bf16_f32 v65, v18, v19
    v_cvt_pk_bf16_f32 v66, v20, v21
    v_cvt_pk_bf16_f32 v67, v22, v23
    v_cvt_pk_bf16_f32 v68, v24, v25
    v_cvt_pk_bf16_f32 v69, v26, v27
    v_cvt_pk_bf16_f32 v70, v28, v29
    v_cvt_pk_bf16_f32 v71, v30, v31
    buffer_store_dwordx4 v[64:67], v15, s[12:15], s26 offen sc1
    buffer_store_dwordx4 v[68:71], v15, s[12:15], s27 offen sc1
    v_cvt_pk_bf16_f32 v72, v32, v33
    v_cvt_pk_bf16_f32 v73, v34, v35
    v_cvt_pk_bf16_f32 v74, v36, v37
    v_cvt_pk_bf16_f32 v75, v38, v39
    v_cvt_pk_bf16_f32 v76, v40, v41
    v_cvt_pk_bf16_f32 v77, v42, v43
    v_cvt_pk_bf16_f32 v78, v44, v45
    v_cvt_pk_bf16_f32 v79, v46, v47
    buffer_store_dwordx4 v[72:75], v7, s[12:15], s26 offen offset:1024 sc1
    buffer_store_dwordx4 v[76:79], v7, s[12:15], s26 offen offset:1536 sc1
    ds_write_b128 v2, v[64:67]
    ds_write_b128 v2, v[68:71] offset:2304
    ds_write_b128 v5, v[72:75] offset:1024
    ds_write_b128 v5, v[76:79] offset:1536
    s_waitcnt lgkmcnt(0)
    s_barrier
    ds_read_b128 v[80:83], v8 offset:0
    ds_read_b64_tr_b16 v[84:85], v13 offset:0
    ds_read_b64_tr_b16 v[86:87], v13 offset:512
    ds_read_b128 v[88:91], v9 offset:0
    ds_read_b64_tr_b16 v[92:93], v13 offset:2048
    ds_read_b64_tr_b16 v[94:95], v13 offset:2560
    ds_read_b128 v[96:99], v10 offset:0
    ds_read_b64_tr_b16 v[100:101], v13 offset:4096
    ds_read_b64_tr_b16 v[102:103], v13 offset:4608
    ds_read_b128 v[104:107], v11 offset:0
    ds_read_b64_tr_b16 v[108:109], v13 offset:6144
    ds_read_b64_tr_b16 v[110:111], v13 offset:6656
    s_waitcnt lgkmcnt(9)
    v_mfma_f32_32x32x16_bf16 v[48:63], v[84:87], v[80:83], v[48:63]
    ds_read_b128 v[80:83], v8 offset:8192
    ds_read_b64_tr_b16 v[84:85], v13 offset:8192
    ds_read_b64_tr_b16 v[86:87], v13 offset:8704
    s_waitcnt lgkmcnt(9)
    v_mfma_f32_32x32x16_bf16 v[48:63], v[92:95], v[88:91], v[48:63]
    ds_read_b128 v[88:91], v9 offset:8192
    ds_read_b64_tr_b16 v[92:93], v13 offset:10240
    ds_read_b64_tr_b16 v[94:95], v13 offset:10752
    s_waitcnt lgkmcnt(9)
    v_mfma_f32_32x32x16_bf16 v[48:63], v[100:103], v[96:99], v[48:63]
    ds_read_b128 v[96:99], v10 offset:8192
    ds_read_b64_tr_b16 v[100:101], v13 offset:12288
    ds_read_b64_tr_b16 v[102:103], v13 offset:12800
    s_waitcnt lgkmcnt(9)
    v_mfma_f32_32x32x16_bf16 v[48:63], v[108:111], v[104:107], v[48:63]
    ds_read_b128 v[104:107], v11 offset:8192
    ds_read_b64_tr_b16 v[108:109], v13 offset:14336
    ds_read_b64_tr_b16 v[110:111], v13 offset:14848
    s_waitcnt lgkmcnt(9)
    v_mfma_f32_32x32x16_bf16 v[48:63], v[84:87], v[80:83], v[48:63]
    ds_read_b128 v[80:83], v8 offset:16384
    ds_read_b64_tr_b16 v[84:85], v13 offset:16384
    ds_read_b64_tr_b16 v[86:87], v13 offset:16896
    s_waitcnt lgkmcnt(9)
    v_mfma_f32_32x32x16_bf16 v[48:63], v[92:95], v[88:91], v[48:63]
    ds_read_b128 v[88:91], v9 offset:16384
    ds_read_b64_tr_b16 v[92:93], v13 offset:18432
    ds_read_b64_tr_b16 v[94:95], v13 offset:18944
    s_waitcnt lgkmcnt(9)
    v_mfma_f32_32x32x16_bf16 v[48:63], v[100:103], v[96:99], v[48:63]
    ds_read_b128 v[96:99], v10 offset:16384
    ds_read_b64_tr_b16 v[100:101], v13 offset:20480
    ds_read_b64_tr_b16 v[102:103], v13 offset:20992
    s_waitcnt lgkmcnt(9)
    v_mfma_f32_32x32x16_bf16 v[48:63], v[108:111], v[104:107], v[48:63]
    ds_read_b128 v[104:107], v11 offset:16384
    ds_read_b64_tr_b16 v[108:109], v13 offset:22528
    ds_read_b64_tr_b16 v[110:111], v13 offset:23040
    s_waitcnt lgkmcnt(9)
    v_mfma_f32_32x32x16_bf16 v[48:63], v[84:87], v[80:83], v[48:63]
    ds_read_b128 v[80:83], v8 offset:24576
    ds_read_b64_tr_b16 v[84:85], v13 offset:24576
    ds_read_b64_tr_b16 v[86:87], v13 offset:25088
    s_waitcnt lgkmcnt(9)
    v_mfma_f32_32x32x16_bf16 v[48:63], v[92:95], v[88:91], v[48:63]
    ds_read_b128 v[88:91], v9 offset:24576
    ds_read_b64_tr_b16 v[92:93], v13 offset:26624
    ds_read_b64_tr_b16 v[94:95], v13 offset:27136
    s_waitcnt lgkmcnt(9)
    v_mfma_f32_32x32x16_bf16 v[48:63], v[100:103], v[96:99], v[48:63]
    ds_read_b128 v[96:99], v10 offset:24576
    ds_read_b64_tr_b16 v[100:101], v13 offset:28672
    ds_read_b64_tr_b16 v[102:103], v13 offset:29184
    s_waitcnt lgkmcnt(9)
    v_mfma_f32_32x32x16_bf16 v[48:63], v[108:111], v[104:107], v[48:63]
    ds_read_b128 v[104:107], v11 offset:24576
    ds_read_b64_tr_b16 v[108:109], v13 offset:30720
    ds_read_b64_tr_b16 v[110:111], v13 offset:31232
    s_waitcnt lgkmcnt(9)
    v_mfma_f32_32x32x16_bf16 v[48:63], v[84:87], v[80:83], v[48:63]
    s_waitcnt lgkmcnt(6)
    v_mfma_f32_32x32x16_bf16 v[48:63], v[92:95], v[88:91], v[48:63]
    s_waitcnt lgkmcnt(3)
    v_mfma_f32_32x32x16_bf16 v[48:63], v[100:103], v[96:99], v[48:63]
    s_waitcnt lgkmcnt(0)
    v_mfma_f32_32x32x16_bf16 v[48:63], v[108:111], v[104:107], v[48:63]
    s_barrier
    ds_read_b128 v[80:83], v8 offset:32768
    ds_read_b64_tr_b16 v[84:85], v13 offset:32768
    ds_read_b64_tr_b16 v[86:87], v13 offset:33280
    ds_read_b128 v[88:91], v9 offset:32768
    ds_read_b64_tr_b16 v[92:93], v13 offset:34816
    ds_read_b64_tr_b16 v[94:95], v13 offset:35328
    ds_read_b128 v[96:99], v10 offset:32768
    ds_read_b64_tr_b16 v[100:101], v13 offset:36864
    ds_read_b64_tr_b16 v[102:103], v13 offset:37376
    ds_read_b128 v[104:107], v11 offset:32768
    ds_read_b64_tr_b16 v[108:109], v13 offset:38912
    ds_read_b64_tr_b16 v[110:111], v13 offset:39424
    s_waitcnt lgkmcnt(9)
    v_mfma_f32_32x32x16_bf16 v[48:63], v[84:87], v[80:83], v[48:63]
    ds_read_b128 v[80:83], v8 offset:40960
    ds_read_b64_tr_b16 v[84:85], v13 offset:40960
    ds_read_b64_tr_b16 v[86:87], v13 offset:41472
    s_waitcnt lgkmcnt(9)
    v_mfma_f32_32x32x16_bf16 v[48:63], v[92:95], v[88:91], v[48:63]
    ds_read_b128 v[88:91], v9 offset:40960
    ds_read_b64_tr_b16 v[92:93], v13 offset:43008
    ds_read_b64_tr_b16 v[94:95], v13 offset:43520
    s_waitcnt lgkmcnt(9)
    v_mfma_f32_32x32x16_bf16 v[48:63], v[100:103], v[96:99], v[48:63]
    ds_read_b128 v[96:99], v10 offset:40960
    ds_read_b64_tr_b16 v[100:101], v13 offset:45056
    ds_read_b64_tr_b16 v[102:103], v13 offset:45568
    s_waitcnt lgkmcnt(9)
    v_mfma_f32_32x32x16_bf16 v[48:63], v[108:111], v[104:107], v[48:63]
    ds_read_b128 v[104:107], v11 offset:40960
    ds_read_b64_tr_b16 v[108:109], v13 offset:47104
    ds_read_b64_tr_b16 v[110:111], v13 offset:47616
    s_waitcnt lgkmcnt(9)
    v_mfma_f32_32x32x16_bf16 v[48:63], v[84:87], v[80:83], v[48:63]
    s_waitcnt lgkmcnt(6)
    v_mfma_f32_32x32x16_bf16 v[48:63], v[92:95], v[88:91], v[48:63]
    s_waitcnt lgkmcnt(3)
    v_mfma_f32_32x32x16_bf16 v[48:63], v[100:103], v[96:99], v[48:63]
    s_waitcnt lgkmcnt(0)
    v_mfma_f32_32x32x16_bf16 v[48:63], v[108:111], v[104:107], v[48:63]
    s_waitcnt vmcnt(0)
    s_barrier
    s_barrier
    ds_read_b128 v[80:83], v8 offset:49152
    ds_read_b64_tr_b16 v[84:85], v13 offset:49152
    ds_read_b64_tr_b16 v[86:87], v13 offset:49664
    ds_read_b128 v[88:91], v9 offset:49152
    ds_read_b64_tr_b16 v[92:93], v13 offset:51200
    ds_read_b64_tr_b16 v[94:95], v13 offset:51712
    ds_read_b128 v[96:99], v10 offset:49152
    ds_read_b64_tr_b16 v[100:101], v13 offset:53248
    ds_read_b64_tr_b16 v[102:103], v13 offset:53760
    ds_read_b128 v[104:107], v11 offset:49152
    ds_read_b64_tr_b16 v[108:109], v13 offset:55296
    ds_read_b64_tr_b16 v[110:111], v13 offset:55808
    s_waitcnt lgkmcnt(9)
    v_mfma_f32_32x32x16_bf16 v[48:63], v[84:87], v[80:83], v[48:63]
    ds_read_b128 v[80:83], v8 offset:57344
    ds_read_b64_tr_b16 v[84:85], v13 offset:57344
    ds_read_b64_tr_b16 v[86:87], v13 offset:57856
    s_waitcnt lgkmcnt(9)
    v_mfma_f32_32x32x16_bf16 v[48:63], v[92:95], v[88:91], v[48:63]
    ds_read_b128 v[88:91], v9 offset:57344
    ds_read_b64_tr_b16 v[92:93], v13 offset:59392
    ds_read_b64_tr_b16 v[94:95], v13 offset:59904
    s_waitcnt lgkmcnt(9)
    v_mfma_f32_32x32x16_bf16 v[48:63], v[100:103], v[96:99], v[48:63]
    ds_read_b128 v[96:99], v10 offset:57344
    ds_read_b64_tr_b16 v[100:101], v13 offset:61440
    ds_read_b64_tr_b16 v[102:103], v13 offset:61952
    s_waitcnt lgkmcnt(9)
    v_mfma_f32_32x32x16_bf16 v[48:63], v[108:111], v[104:107], v[48:63]
    ds_read_b128 v[104:107], v11 offset:57344
    ds_read_b64_tr_b16 v[108:109], v13 offset:63488
    ds_read_b64_tr_b16 v[110:111], v13 offset:64000
    s_waitcnt lgkmcnt(9)
    v_mfma_f32_32x32x16_bf16 v[48:63], v[84:87], v[80:83], v[48:63]
    s_waitcnt lgkmcnt(6)
    v_mfma_f32_32x32x16_bf16 v[48:63], v[92:95], v[88:91], v[48:63]
    s_waitcnt lgkmcnt(3)
    v_mfma_f32_32x32x16_bf16 v[48:63], v[100:103], v[96:99], v[48:63]
    s_waitcnt lgkmcnt(0)
    v_mfma_f32_32x32x16_bf16 v[48:63], v[108:111], v[104:107], v[48:63]
    s_nop 1
    s_nop 9
    v_pk_mul_f32 v[48:49], v[48:49], s[30:31]
    v_pk_mul_f32 v[50:51], v[50:51], s[30:31]
    v_pk_mul_f32 v[52:53], v[52:53], s[30:31]
    v_pk_mul_f32 v[54:55], v[54:55], s[30:31]
    v_pk_mul_f32 v[56:57], v[56:57], s[30:31]
    v_pk_mul_f32 v[58:59], v[58:59], s[30:31]
    v_pk_mul_f32 v[60:61], v[60:61], s[30:31]
    v_pk_mul_f32 v[62:63], v[62:63], s[30:31]
    v_cvt_pk_bf16_f32 v16, v48, v49
    v_cvt_pk_bf16_f32 v17, v50, v51
    v_cvt_pk_bf16_f32 v18, v52, v53
    v_cvt_pk_bf16_f32 v19, v54, v55
    v_cvt_pk_bf16_f32 v20, v56, v57
    v_cvt_pk_bf16_f32 v21, v58, v59
    v_cvt_pk_bf16_f32 v22, v60, v61
    v_cvt_pk_bf16_f32 v23, v62, v63
    ds_write_b128 v14, v[16:19]
    ds_write_b128 v14, v[20:23] offset:2048
L_b10:
    ds_read_b128 v[88:91], v144
    s_mov_b64 exec, s[52:53]
    ds_read_b128 v[112:115], v145 offset:1024
    ds_read_b128 v[116:119], v145 offset:1536
    s_mov_b64 exec, -1
    v_mov_b32 v104, 0
    v_mov_b32 v105, 0
    v_mov_b32 v106, 0
    v_mov_b32 v107, 0
    v_xor_b32 v3, 1024, v151
    v_mov_b32 v8, 157712
    v_mfma_f32_32x32x16_bf16 v[48:63], v[104:107], v[104:107], 0
    v_mfma_f32_32x32x16_bf16 v[64:79], v[104:107], v[104:107], 0
    s_setprio 3
    s_waitcnt lgkmcnt(0)
    s_barrier
    ds_read_b32 v9, v8
    ds_read_b128 v[80:83], v3
    ds_read_b128 v[84:87], v151
    s_waitcnt lgkmcnt(2)
    v_readfirstlane_b32 s94, v9
    s_waitcnt lgkmcnt(1)
    v_mfma_f32_32x32x16_bf16 v[16:31], v[88:91], v[80:83], 0
    s_not_b32 s95, s94
    s_andn2_b32 s94, s94, s49
    s_mov_b32 s96, 0
    s_waitcnt lgkmcnt(0)
    v_mfma_f32_32x32x16_bf16 v[32:47], v[88:91], v[84:87], 0
    s_ff1_i32_b64 s96, s[94:95]
    s_bitset0_b64 s[94:95], s96
    s_lshl_b32 s97, s96, 12
    s_and_b32 s97, s97, 0x8001f000
    buffer_load_dwordx4 v[92:95], v149, s[8:11], s97 offen sc1
    s_mov_b64 exec, s[52:53]
    buffer_load_dwordx4 v[120:123], v148, s[8:11], s97 offen offset:1024 sc1
    buffer_load_dwordx4 v[124:127], v148, s[8:11], s97 offen offset:1536 sc1
    s_mov_b64 exec, -1
    v_exp_f32 v16, v16
    v_exp_f32 v17, v17
    v_exp_f32 v18, v18
    v_exp_f32 v19, v19
    v_exp_f32 v20, v20
    v_exp_f32 v21, v21
    v_exp_f32 v22, v22
    v_exp_f32 v23, v23
    v_exp_f32 v24, v24
    v_exp_f32 v25, v25
    v_exp_f32 v26, v26
    v_exp_f32 v27, v27
    v_exp_f32 v28, v28
    v_exp_f32 v29, v29
    v_exp_f32 v30, v30
    v_exp_f32 v31, v31
    s_ff1_i32_b64 s96, s[94:95]
    s_bitset0_b64 s[94:95], s96
    s_lshl_b32 s97, s96, 12
    s_and_b32 s97, s97, 0x8001f000
    buffer_load_dwordx4 v[96:99], v149, s[8:11], s97 offen sc1
    s_mov_b64 exec, s[52:53]
    buffer_load_dwordx4 v[128:131], v148, s[8:11], s97 offen offset:1024 sc1
    buffer_load_dwordx4 v[132:135], v148, s[8:11], s97 offen offset:1536 sc1
    s_mov_b64 exec, -1
    v_exp_f32 v32, v32
    v_exp_f32 v33, v33
    v_smfmac_f32_32x32x32_bf16 v[48:63], v[112:115], v[16:23], v147
    v_exp_f32 v34, v34
    v_exp_f32 v35, v35
    v_exp_f32 v36, v36
    v_exp_f32 v37, v37
    v_smfmac_f32_32x32x32_bf16 v[48:63], v[116:119], v[24:31], v147
    v_exp_f32 v38, v38
    v_exp_f32 v39, v39
    v_exp_f32 v40, v40
    v_exp_f32 v41, v41
    s_waitcnt vmcnt(5)
    v_mfma_f32_32x32x16_bf16 v[16:31], v[92:95], v[80:83], 0
    v_exp_f32 v42, v42
    v_exp_f32 v43, v43
    v_exp_f32 v44, v44
    v_exp_f32 v45, v45
    v_exp_f32 v46, v46
    v_exp_f32 v47, v47
    s_ff1_i32_b64 s96, s[94:95]
    s_bitset0_b64 s[94:95], s96
    s_lshl_b32 s97, s96, 12
    s_and_b32 s97, s97, 0x8001f000
    buffer_load_dwordx4 v[100:103], v149, s[8:11], s97 offen sc1
    s_setprio 2
    v_smfmac_f32_32x32x32_bf16 v[64:79], v[112:115], v[32:39], v147
    v_exp_f32 v16, v16
    v_exp_f32 v17, v17
    v_exp_f32 v18, v18
    v_smfmac_f32_32x32x32_bf16 v[64:79], v[116:119], v[40:47], v147
    v_exp_f32 v19, v19
    v_exp_f32 v20, v20
    v_exp_f32 v21, v21
    v_mfma_f32_32x32x16_bf16 v[32:47], v[92:95], v[84:87], 0
    v_exp_f32 v22, v22
    v_exp_f32 v23, v23
    v_exp_f32 v24, v24
    v_exp_f32 v25, v25
    s_mov_b64 exec, s[52:53]
    buffer_load_dwordx4 v[136:139], v148, s[8:11], s97 offen offset:1024 sc1
    buffer_load_dwordx4 v[140:143], v148, s[8:11], s97 offen offset:1536 sc1
    s_mov_b64 exec, -1
    s_ff1_i32_b64 s96, s[94:95]
    s_bitset0_b64 s[94:95], s96
    s_lshl_b32 s97, s96, 12
    s_and_b32 s97, s97, 0x8001f000
    buffer_load_dwordx4 v[88:91], v149, s[8:11], s97 offen sc1
    s_mov_b64 exec, s[52:53]
    buffer_load_dwordx4 v[112:115], v148, s[8:11], s97 offen offset:1024 sc1
    buffer_load_dwordx4 v[116:119], v148, s[8:11], s97 offen offset:1536 sc1
    s_mov_b64 exec, -1
    v_exp_f32 v26, v26
    v_exp_f32 v27, v27
    s_setprio 2
    v_exp_f32 v28, v28
    v_exp_f32 v29, v29
    v_exp_f32 v30, v30
    v_exp_f32 v31, v31
    s_waitcnt vmcnt(9)
    v_smfmac_f32_32x32x32_bf16 v[48:63], v[120:123], v[16:23], v147
    v_exp_f32 v32, v32
    v_exp_f32 v33, v33
    v_exp_f32 v34, v34
    v_smfmac_f32_32x32x32_bf16 v[48:63], v[124:127], v[24:31], v147
    v_exp_f32 v35, v35
    v_exp_f32 v36, v36
    v_exp_f32 v37, v37
    s_waitcnt vmcnt(8)
    v_mfma_f32_32x32x16_bf16 v[16:31], v[96:99], v[80:83], 0
    v_exp_f32 v38, v38
    v_exp_f32 v39, v39
    v_exp_f32 v40, v40
    v_exp_f32 v41, v41
    s_ff1_i32_b64 s96, s[94:95]
    s_bitset0_b64 s[94:95], s96
    s_lshl_b32 s97, s96, 12
    s_and_b32 s97, s97, 0x8001f000
    buffer_load_dwordx4 v[92:95], v149, s[8:11], s97 offen sc1
    v_exp_f32 v42, v42
    v_exp_f32 v43, v43
    v_exp_f32 v44, v44
    v_exp_f32 v45, v45
    v_exp_f32 v46, v46
    v_exp_f32 v47, v47
    v_smfmac_f32_32x32x32_bf16 v[64:79], v[120:123], v[32:39], v147
    v_exp_f32 v16, v16
    v_exp_f32 v17, v17
    v_exp_f32 v18, v18
    v_smfmac_f32_32x32x32_bf16 v[64:79], v[124:127], v[40:47], v147
    v_exp_f32 v19, v19
    v_exp_f32 v20, v20
    v_exp_f32 v21, v21
    v_mfma_f32_32x32x16_bf16 v[32:47], v[96:99], v[84:87], 0
    v_exp_f32 v22, v22
    v_exp_f32 v23, v23
    v_exp_f32 v24, v24
    v_exp_f32 v25, v25
    s_mov_b64 exec, s[52:53]
    buffer_load_dwordx4 v[120:123], v148, s[8:11], s97 offen offset:1024 sc1
    buffer_load_dwordx4 v[124:127], v148, s[8:11], s97 offen offset:1536 sc1
    s_mov_b64 exec, -1
    ds_read_b32 v9, v8
    v_exp_f32 v26, v26
    v_exp_f32 v27, v27
    s_setprio 1
    v_exp_f32 v28, v28
    v_exp_f32 v29, v29
    v_exp_f32 v30, v30
    v_exp_f32 v31, v31
    s_waitcnt vmcnt(9)
    v_smfmac_f32_32x32x32_bf16 v[48:63], v[128:131], v[16:23], v147
    v_exp_f32 v32, v32
    v_exp_f32 v33, v33
    v_exp_f32 v34, v34
    v_smfmac_f32_32x32x32_bf16 v[48:63], v[132:135], v[24:31], v147
    v_exp_f32 v35, v35
    v_exp_f32 v36, v36
    v_exp_f32 v37, v37
    s_waitcnt vmcnt(8)
    v_mfma_f32_32x32x16_bf16 v[16:31], v[100:103], v[80:83], 0
    v_exp_f32 v38, v38
    v_exp_f32 v39, v39
    v_exp_f32 v40, v40
    v_exp_f32 v41, v41
    s_ff1_i32_b64 s96, s[94:95]
    s_bitset0_b64 s[94:95], s96
    s_lshl_b32 s97, s96, 12
    s_and_b32 s97, s97, 0x8001f000
    buffer_load_dwordx4 v[96:99], v149, s[8:11], s97 offen sc1
    v_exp_f32 v42, v42
    v_exp_f32 v43, v43
    v_exp_f32 v44, v44
    v_exp_f32 v45, v45
    v_exp_f32 v46, v46
    v_exp_f32 v47, v47
    s_waitcnt lgkmcnt(0)
L_full:
    v_readfirstlane_b32 s30, v9
    s_cmp_eq_u32 s30, -1
    s_cbranch_scc1 L_loopin
    ds_read_b32 v9, v8
    s_sleep 2
    s_waitcnt lgkmcnt(0)
    s_branch L_full
.p2align 6
L_loop:
    v_smfmac_f32_32x32x32_bf16 v[64:79], v[136:139], v[32:39], v147
    v_exp_f32 v16, v16
    v_exp_f32 v17, v17
    v_exp_f32 v18, v18
    v_smfmac_f32_32x32x32_bf16 v[64:79], v[140:143], v[40:47], v147
    v_exp_f32 v19, v19
    v_exp_f32 v20, v20
    v_exp_f32 v21, v21
    v_mfma_f32_32x32x16_bf16 v[32:47], v[88:91], v[84:87], 0
    v_exp_f32 v22, v22
    v_exp_f32 v23, v23
    v_exp_f32 v24, v24
    v_exp_f32 v25, v25
    s_mov_b64 exec, s[52:53]
    buffer_load_dwordx4 v[136:139], v148, s[8:11], s97 offen offset:1024 sc1
    buffer_load_dwordx4 v[140:143], v148, s[8:11], s97 offen offset:1536 sc1
    s_mov_b64 exec, -1
    v_exp_f32 v26, v26
    v_exp_f32 v27, v27
    s_setprio 3
    v_exp_f32 v28, v28
    v_exp_f32 v29, v29
    v_exp_f32 v30, v30
    v_exp_f32 v31, v31
    s_waitcnt vmcnt(9)
    v_smfmac_f32_32x32x32_bf16 v[48:63], v[112:115], v[16:23], v147
    v_exp_f32 v32, v32
    v_exp_f32 v33, v33
    v_exp_f32 v34, v34
    v_smfmac_f32_32x32x32_bf16 v[48:63], v[116:119], v[24:31], v147
    v_exp_f32 v35, v35
    v_exp_f32 v36, v36
    v_exp_f32 v37, v37
    s_waitcnt vmcnt(8)
    v_mfma_f32_32x32x16_bf16 v[16:31], v[92:95], v[80:83], 0
    v_exp_f32 v38, v38
    v_exp_f32 v39, v39
    v_exp_f32 v40, v40
    v_exp_f32 v41, v41
    s_ff1_i32_b64 s96, s[94:95]
    s_bitset0_b64 s[94:95], s96
    s_lshl_b32 s97, s96, 12
    s_and_b32 s97, s97, 0x8001f000
    buffer_load_dwordx4 v[88:91], v149, s[8:11], s97 offen sc1
    v_exp_f32 v42, v42
    v_exp_f32 v43, v43
    v_exp_f32 v44, v44
    v_exp_f32 v45, v45
    v_exp_f32 v46, v46
    v_exp_f32 v47, v47
    v_smfmac_f32_32x32x32_bf16 v[64:79], v[112:115], v[32:39], v147
    v_exp_f32 v16, v16
    v_exp_f32 v17, v17
    v_exp_f32 v18, v18
    v_smfmac_f32_32x32x32_bf16 v[64:79], v[116:119], v[40:47], v147
    v_exp_f32 v19, v19
    v_exp_f32 v20, v20
    v_exp_f32 v21, v21
    v_mfma_f32_32x32x16_bf16 v[32:47], v[92:95], v[84:87], 0
    v_exp_f32 v22, v22
    v_exp_f32 v23, v23
    v_exp_f32 v24, v24
    v_exp_f32 v25, v25
    s_mov_b64 exec, s[52:53]
    buffer_load_dwordx4 v[112:115], v148, s[8:11], s97 offen offset:1024 sc1
    buffer_load_dwordx4 v[116:119], v148, s[8:11], s97 offen offset:1536 sc1
    s_mov_b64 exec, -1
    v_exp_f32 v26, v26
    v_exp_f32 v27, v27
    s_setprio 2
    v_exp_f32 v28, v28
    v_exp_f32 v29, v29
    v_exp_f32 v30, v30
    v_exp_f32 v31, v31
    s_waitcnt vmcnt(9)
    v_smfmac_f32_32x32x32_bf16 v[48:63], v[120:123], v[16:23], v147
    v_exp_f32 v32, v32
    v_exp_f32 v33, v33
    v_exp_f32 v34, v34
    v_smfmac_f32_32x32x32_bf16 v[48:63], v[124:127], v[24:31], v147
    v_exp_f32 v35, v35
    v_exp_f32 v36, v36
    v_exp_f32 v37, v37
    s_waitcnt vmcnt(8)
    v_mfma_f32_32x32x16_bf16 v[16:31], v[96:99], v[80:83], 0
    v_exp_f32 v38, v38
    v_exp_f32 v39, v39
    v_exp_f32 v40, v40
    v_exp_f32 v41, v41
    s_ff1_i32_b64 s96, s[94:95]
    s_bitset0_b64 s[94:95], s96
    s_lshl_b32 s97, s96, 12
    s_and_b32 s97, s97, 0x8001f000
    buffer_load_dwordx4 v[92:95], v149, s[8:11], s97 offen sc1
    v_exp_f32 v42, v42
    v_exp_f32 v43, v43
    v_exp_f32 v44, v44
    v_exp_f32 v45, v45
    v_exp_f32 v46, v46
    v_exp_f32 v47, v47
    v_smfmac_f32_32x32x32_bf16 v[64:79], v[120:123], v[32:39], v147
    v_exp_f32 v16, v16
    v_exp_f32 v17, v17
    v_exp_f32 v18, v18
    v_smfmac_f32_32x32x32_bf16 v[64:79], v[124:127], v[40:47], v147
    v_exp_f32 v19, v19
    v_exp_f32 v20, v20
    v_exp_f32 v21, v21
    v_mfma_f32_32x32x16_bf16 v[32:47], v[96:99], v[84:87], 0
    v_exp_f32 v22, v22
    v_exp_f32 v23, v23
    v_exp_f32 v24, v24
    v_exp_f32 v25, v25
    s_mov_b64 exec, s[52:53]
    buffer_load_dwordx4 v[120:123], v148, s[8:11], s97 offen offset:1024 sc1
    buffer_load_dwordx4 v[124:127], v148, s[8:11], s97 offen offset:1536 sc1
    s_mov_b64 exec, -1
    v_exp_f32 v26, v26
    v_exp_f32 v27, v27
    s_setprio 1
    v_exp_f32 v28, v28
    v_exp_f32 v29, v29
    v_exp_f32 v30, v30
    v_exp_f32 v31, v31
    s_waitcnt vmcnt(9)
    v_smfmac_f32_32x32x32_bf16 v[48:63], v[128:131], v[16:23], v147
    v_exp_f32 v32, v32
    v_exp_f32 v33, v33
    v_exp_f32 v34, v34
    v_smfmac_f32_32x32x32_bf16 v[48:63], v[132:135], v[24:31], v147
    v_exp_f32 v35, v35
    v_exp_f32 v36, v36
    v_exp_f32 v37, v37
    s_waitcnt vmcnt(8)
    v_mfma_f32_32x32x16_bf16 v[16:31], v[100:103], v[80:83], 0
    v_exp_f32 v38, v38
    v_exp_f32 v39, v39
    v_exp_f32 v40, v40
    v_exp_f32 v41, v41
    s_ff1_i32_b64 s96, s[94:95]
    s_bitset0_b64 s[94:95], s96
    s_lshl_b32 s97, s96, 12
    s_and_b32 s97, s97, 0x8001f000
    buffer_load_dwordx4 v[96:99], v149, s[8:11], s97 offen sc1
    v_exp_f32 v42, v42
    v_exp_f32 v43, v43
    v_exp_f32 v44, v44
    v_exp_f32 v45, v45
    v_exp_f32 v46, v46
    v_exp_f32 v47, v47
L_loopin:
    v_smfmac_f32_32x32x32_bf16 v[64:79], v[128:131], v[32:39], v147
    v_exp_f32 v16, v16
    v_exp_f32 v17, v17
    v_exp_f32 v18, v18
    v_smfmac_f32_32x32x32_bf16 v[64:79], v[132:135], v[40:47], v147
    v_exp_f32 v19, v19
    v_exp_f32 v20, v20
    v_exp_f32 v21, v21
    v_mfma_f32_32x32x16_bf16 v[32:47], v[100:103], v[84:87], 0
    v_exp_f32 v22, v22
    v_exp_f32 v23, v23
    v_exp_f32 v24, v24
    v_exp_f32 v25, v25
    s_mov_b64 exec, s[52:53]
    buffer_load_dwordx4 v[128:131], v148, s[8:11], s97 offen offset:1024 sc1
    buffer_load_dwordx4 v[132:135], v148, s[8:11], s97 offen offset:1536 sc1
    s_mov_b64 exec, -1
    v_exp_f32 v26, v26
    v_exp_f32 v27, v27
    s_setprio 0
    v_exp_f32 v28, v28
    v_exp_f32 v29, v29
    v_exp_f32 v30, v30
    v_exp_f32 v31, v31
    s_waitcnt vmcnt(9)
    v_smfmac_f32_32x32x32_bf16 v[48:63], v[136:139], v[16:23], v147
    v_exp_f32 v32, v32
    v_exp_f32 v33, v33
    v_exp_f32 v34, v34
    v_smfmac_f32_32x32x32_bf16 v[48:63], v[140:143], v[24:31], v147
    v_exp_f32 v35, v35
    v_exp_f32 v36, v36
    v_exp_f32 v37, v37
    s_waitcnt vmcnt(8)
    v_mfma_f32_32x32x16_bf16 v[16:31], v[88:91], v[80:83], 0
    v_exp_f32 v38, v38
    v_exp_f32 v39, v39
    v_exp_f32 v40, v40
    v_exp_f32 v41, v41
    s_ff1_i32_b64 s96, s[94:95]
    s_bitset0_b64 s[94:95], s96
    s_lshl_b32 s97, s96, 12
    s_and_b32 s97, s97, 0x8001f000
    buffer_load_dwordx4 v[100:103], v149, s[8:11], s97 offen sc1
    v_exp_f32 v42, v42
    v_exp_f32 v43, v43
    s_sub_u32 s50, s50, 1
    s_cmp_lg_u32 s50, 0
    v_exp_f32 v44, v44
    v_exp_f32 v45, v45
    v_exp_f32 v46, v46
    v_exp_f32 v47, v47
    s_cbranch_scc1 L_loop
    s_setprio 0
    v_smfmac_f32_32x32x32_bf16 v[64:79], v[136:139], v[32:39], v147
    v_smfmac_f32_32x32x32_bf16 v[64:79], v[140:143], v[40:47], v147
    ds_write_b32 v154, v56 offset:2048
    ds_write_b128 v144, v[48:51]
    ds_write_b128 v144, v[52:55] offset:1024
    s_waitcnt lgkmcnt(0)
    v_mov_b32 v154, 0x57800000
    s_barrier
    ds_read_b32 v24, v153 offset:2048
    ds_read_b128 v[16:19], v152
    ds_read_b128 v[20:23], v152 offset:1024
    s_nop 3
    s_waitcnt lgkmcnt(2)
    v_add_f32 v72, v72, v24
    v_rcp_f32 v2, v72
    s_waitcnt vmcnt(0) lgkmcnt(0)
    v_pk_add_f32 v[64:65], v[64:65], v[16:17]
    v_pk_add_f32 v[66:67], v[66:67], v[18:19]
    v_pk_add_f32 v[68:69], v[68:69], v[20:21]
    v_pk_add_f32 v[70:71], v[70:71], v[22:23]
    v_pk_mul_f32 v[16:17], v[64:65], v[2:3] op_sel_hi:[1,0]
    v_pk_mul_f32 v[18:19], v[66:67], v[2:3] op_sel_hi:[1,0]
    v_pk_mul_f32 v[20:21], v[68:69], v[2:3] op_sel_hi:[1,0]
    v_pk_mul_f32 v[22:23], v[70:71], v[2:3] op_sel_hi:[1,0]
    v_pk_fma_f32 v[12:13], v[64:65], 0, v[72:73] op_sel_hi:[1,1,0]
    v_cvt_pk_bf16_f32 v4, v16, v17
    v_pk_fma_f32 v[12:13], v[66:67], 0, v[12:13]
    v_cvt_pk_bf16_f32 v5, v18, v19
    v_pk_fma_f32 v[12:13], v[68:69], 0, v[12:13]
    v_cvt_pk_bf16_f32 v6, v20, v21
    v_pk_fma_f32 v[12:13], v[70:71], 0, v[12:13]
    v_cvt_pk_bf16_f32 v7, v22, v23
    v_cmp_nle_f32 vcc, 0x33800000, v12
    v_cmp_nle_f32 s[30:31], v13, v154
    s_or_b64 vcc, vcc, s[30:31]
    s_cbranch_vccnz L_fallback
L_fin:
    buffer_store_dwordx4 v[4:7], v15, s[12:15], s51 offen sc1
    v_mov_b32 v8, 157716
    s_cmp_lt_u32 s20, 4
    s_cbranch_scc1 L_p3
    s_barrier
    ds_read_b32 v9, v8
    s_waitcnt lgkmcnt(0)
    v_readfirstlane_b32 s94, v9
    s_nop 1
    s_xor_b32 s95, s94, 0xff
    s_bcnt1_i32_b32 s32, s94
    s_min_u32 s32, s32, 8
    s_sub_u32 s33, 8, s32
    s_cmp_eq_u32 s32, 0
    s_cbranch_scc1 L_ol1_x
L_ol1:
    s_ff1_i32_b64 s30, s[94:95]
    s_bitset0_b64 s[94:95], s30
    s_and_b32 s30, s30, 7
    s_lshl_b32 s31, s30, 13
    s_add_u32 m0, s31, s67
    s_lshl_b32 s30, s30, 12
    s_add_u32 s30, s30, s66
    s_add_u32 s31, s30, 31744
    buffer_load_dwordx4 v15, s[12:15], s30 offen sc1 lds
    buffer_load_dwordx4 v15, s[12:15], s31 offen offset:1024 sc1 lds
    s_sub_u32 s32, s32, 1
    s_cmp_lg_u32 s32, 0
    s_cbranch_scc1 L_ol1
L_ol1_x:
    s_barrier
    s_cmp_eq_u32 s33, 0
    s_cbranch_scc1 L_ol2_x
L_ol2:
    s_ff1_i32_b64 s30, s[94:95]
    s_bitset0_b64 s[94:95], s30
    s_and_b32 s30, s30, 7
    s_lshl_b32 s31, s30, 13
    s_add_u32 m0, s31, s67
    s_lshl_b32 s30, s30, 12
    s_add_u32 s30, s30, s66
    s_add_u32 s31, s30, 31744
    buffer_load_dwordx4 v15, s[12:15], s30 offen sc1 lds
    buffer_load_dwordx4 v15, s[12:15], s31 offen offset:1024 sc1 lds
    s_sub_u32 s33, s33, 1
    s_cmp_lg_u32 s33, 0
    s_cbranch_scc1 L_ol2
L_ol2_x:
    s_waitcnt vmcnt(12)
    s_barrier
    s_waitcnt vmcnt(8)
    s_barrier
    s_waitcnt vmcnt(4)
    s_barrier
    s_waitcnt vmcnt(0)
    s_barrier
    s_endpgm
L_p3:
    v_mov_b32 v12, 157696
    v_lshl_add_u32 v14, v158, 2, v12
    ds_read_b32 v10, v14 offset:768
    ds_read_b64 v[6:7], v12
    s_mov_b32 s16, s54
    s_mov_b32 s17, s55
    s_mov_b32 s18, 0x200000
    s_mov_b32 s19, 0x20000
    s_barrier
    ds_read_b32 v9, v8
    s_waitcnt lgkmcnt(0)
    v_readfirstlane_b32 s94, v9
    s_nop 1
    s_xor_b32 s95, s94, 0xff
    s_ff1_i32_b64 s30, s[94:95]
    s_bitset0_b64 s[94:95], s30
    s_and_b32 s30, s30, 7
    s_lshl_b32 s30, s30, 13
    v_add_u32 v8, s30, v156
    v_add_u32 v144, s30, v157
    ds_read_b64_tr_b16 v[32:33], v8 offset:0
    ds_read_b64_tr_b16 v[34:35], v8 offset:1024
    ds_read_b64_tr_b16 v[36:37], v8 offset:2048
    ds_read_b64_tr_b16 v[38:39], v8 offset:3072
    ds_read_b64_tr_b16 v[40:41], v8 offset:4096
    ds_read_b64_tr_b16 v[42:43], v8 offset:5120
    ds_read_b64_tr_b16 v[44:45], v8 offset:6144
    ds_read_b64_tr_b16 v[46:47], v8 offset:7168
    s_ff1_i32_b64 s30, s[94:95]
    s_bitset0_b64 s[94:95], s30
    s_and_b32 s30, s30, 7
    s_lshl_b32 s30, s30, 13
    v_add_u32 v8, s30, v156
    v_add_u32 v145, s30, v157
    s_waitcnt lgkmcnt(6)
    ds_read_b64_tr_b16 v[48:49], v8 offset:0
    ds_read_b64_tr_b16 v[50:51], v8 offset:1024
    ds_read_b64_tr_b16 v[52:53], v8 offset:2048
    ds_read_b64_tr_b16 v[54:55], v8 offset:3072
    ds_read_b64_tr_b16 v[56:57], v8 offset:4096
    ds_read_b64_tr_b16 v[58:59], v8 offset:5120
    ds_read_b64_tr_b16 v[60:61], v8 offset:6144
    ds_read_b64_tr_b16 v[62:63], v8 offset:7168
    s_ff1_i32_b64 s30, s[94:95]
    s_bitset0_b64 s[94:95], s30
    s_and_b32 s30, s30, 7
    s_lshl_b32 s30, s30, 13
    v_add_u32 v8, s30, v156
    v_add_u32 v146, s30, v157
    s_waitcnt lgkmcnt(6)
    ds_read_b64_tr_b16 v[64:65], v8 offset:0
    ds_read_b64_tr_b16 v[66:67], v8 offset:1024
    ds_read_b64_tr_b16 v[68:69], v8 offset:2048
    ds_read_b64_tr_b16 v[70:71], v8 offset:3072
    ds_read_b64_tr_b16 v[72:73], v8 offset:4096
    ds_read_b64_tr_b16 v[74:75], v8 offset:5120
    ds_read_b64_tr_b16 v[76:77], v8 offset:6144
    ds_read_b64_tr_b16 v[78:79], v8 offset:7168
    s_ff1_i32_b64 s30, s[94:95]
    s_bitset0_b64 s[94:95], s30
    s_and_b32 s30, s30, 7
    s_lshl_b32 s30, s30, 13
    v_add_u32 v8, s30, v156
    v_add_u32 v147, s30, v157
    s_waitcnt lgkmcnt(6)
    ds_read_b64_tr_b16 v[80:81], v8 offset:0
    ds_read_b64_tr_b16 v[82:83], v8 offset:1024
    ds_read_b64_tr_b16 v[84:85], v8 offset:2048
    ds_read_b64_tr_b16 v[86:87], v8 offset:3072
    ds_read_b64_tr_b16 v[88:89], v8 offset:4096
    ds_read_b64_tr_b16 v[90:91], v8 offset:5120
    ds_read_b64_tr_b16 v[92:93], v8 offset:6144
    ds_read_b64_tr_b16 v[94:95], v8 offset:7168
    s_ff1_i32_b64 s30, s[94:95]
    s_bitset0_b64 s[94:95], s30
    s_and_b32 s30, s30, 7
    s_lshl_b32 s30, s30, 13
    v_add_u32 v8, s30, v156
    v_add_u32 v148, s30, v157
    s_waitcnt lgkmcnt(6)
    ds_read_b64_tr_b16 v[96:97], v8 offset:0
    ds_read_b64_tr_b16 v[98:99], v8 offset:1024
    ds_read_b64_tr_b16 v[100:101], v8 offset:2048
    ds_read_b64_tr_b16 v[102:103], v8 offset:3072
    ds_read_b64_tr_b16 v[104:105], v8 offset:4096
    ds_read_b64_tr_b16 v[106:107], v8 offset:5120
    ds_read_b64_tr_b16 v[108:109], v8 offset:6144
    ds_read_b64_tr_b16 v[110:111], v8 offset:7168
    s_ff1_i32_b64 s30, s[94:95]
    s_bitset0_b64 s[94:95], s30
    s_and_b32 s30, s30, 7
    s_lshl_b32 s30, s30, 13
    v_add_u32 v2, s30, v156
    v_add_u32 v149, s30, v157
    s_ff1_i32_b64 s30, s[94:95]
    s_bitset0_b64 s[94:95], s30
    s_and_b32 s30, s30, 7
    s_lshl_b32 s30, s30, 13
    v_add_u32 v3, s30, v156
    v_add_u32 v150, s30, v157
    s_ff1_i32_b64 s30, s[94:95]
    s_bitset0_b64 s[94:95], s30
    s_and_b32 s30, s30, 7
    s_lshl_b32 s30, s30, 13
    v_add_u32 v4, s30, v156
    v_add_u32 v151, s30, v157
    s_waitcnt vmcnt(0)
    s_barrier
    s_barrier
    s_waitcnt lgkmcnt(0)
    ds_read_b128 v[128:131], v144 offset:0
    ds_read_b128 v[132:135], v144 offset:2048
    ds_read_b128 v[136:139], v144 offset:4096
    ds_read_b128 v[140:143], v144 offset:6144
    s_waitcnt lgkmcnt(3)
    v_mfma_f32_32x32x16_bf16 v[16:31], v[32:35], v[128:131], 0
    ds_read_b128 v[128:131], v145 offset:0
    ds_read_b64_tr_b16 v[32:33], v2 offset:0
    ds_read_b64_tr_b16 v[34:35], v2 offset:1024
    s_waitcnt lgkmcnt(5)
    v_mfma_f32_32x32x16_bf16 v[16:31], v[36:39], v[132:135], v[16:31]
    ds_read_b128 v[132:135], v145 offset:2048
    ds_read_b64_tr_b16 v[36:37], v2 offset:2048
    ds_read_b64_tr_b16 v[38:39], v2 offset:3072
    s_waitcnt lgkmcnt(7)
    v_mfma_f32_32x32x16_bf16 v[16:31], v[40:43], v[136:139], v[16:31]
    ds_read_b128 v[136:139], v145 offset:4096
    ds_read_b64_tr_b16 v[40:41], v2 offset:4096
    ds_read_b64_tr_b16 v[42:43], v2 offset:5120
    s_waitcnt lgkmcnt(9)
    v_mfma_f32_32x32x16_bf16 v[16:31], v[44:47], v[140:143], v[16:31]
    ds_read_b128 v[140:143], v145 offset:6144
    ds_read_b64_tr_b16 v[44:45], v2 offset:6144
    ds_read_b64_tr_b16 v[46:47], v2 offset:7168
    s_barrier
    s_waitcnt lgkmcnt(11)
    v_mfma_f32_32x32x16_bf16 v[16:31], v[48:51], v[128:131], v[16:31]
    ds_read_b128 v[128:131], v146 offset:0
    ds_read_b64_tr_b16 v[48:49], v3 offset:0
    ds_read_b64_tr_b16 v[50:51], v3 offset:1024
    s_waitcnt lgkmcnt(11)
    v_mfma_f32_32x32x16_bf16 v[16:31], v[52:55], v[132:135], v[16:31]
    ds_read_b128 v[132:135], v146 offset:2048
    ds_read_b64_tr_b16 v[52:53], v3 offset:2048
    ds_read_b64_tr_b16 v[54:55], v3 offset:3072
    s_waitcnt lgkmcnt(11)
    v_mfma_f32_32x32x16_bf16 v[16:31], v[56:59], v[136:139], v[16:31]
    ds_read_b128 v[136:139], v146 offset:4096
    ds_read_b64_tr_b16 v[56:57], v3 offset:4096
    ds_read_b64_tr_b16 v[58:59], v3 offset:5120
    s_waitcnt lgkmcnt(11)
    v_mfma_f32_32x32x16_bf16 v[16:31], v[60:63], v[140:143], v[16:31]
    ds_read_b128 v[140:143], v146 offset:6144
    ds_read_b64_tr_b16 v[60:61], v3 offset:6144
    ds_read_b64_tr_b16 v[62:63], v3 offset:7168
    s_waitcnt lgkmcnt(11)
    v_mfma_f32_32x32x16_bf16 v[16:31], v[64:67], v[128:131], v[16:31]
    ds_read_b128 v[128:131], v147 offset:0
    ds_read_b64_tr_b16 v[64:65], v4 offset:0
    ds_read_b64_tr_b16 v[66:67], v4 offset:1024
    s_waitcnt lgkmcnt(11)
    v_mfma_f32_32x32x16_bf16 v[16:31], v[68:71], v[132:135], v[16:31]
    ds_read_b128 v[132:135], v147 offset:2048
    ds_read_b64_tr_b16 v[68:69], v4 offset:2048
    ds_read_b64_tr_b16 v[70:71], v4 offset:3072
    s_waitcnt lgkmcnt(11)
    v_mfma_f32_32x32x16_bf16 v[16:31], v[72:75], v[136:139], v[16:31]
    ds_read_b128 v[136:139], v147 offset:4096
    ds_read_b64_tr_b16 v[72:73], v4 offset:4096
    ds_read_b64_tr_b16 v[74:75], v4 offset:5120
    s_waitcnt lgkmcnt(11)
    v_mfma_f32_32x32x16_bf16 v[16:31], v[76:79], v[140:143], v[16:31]
    ds_read_b128 v[140:143], v147 offset:6144
    ds_read_b64_tr_b16 v[76:77], v4 offset:6144
    ds_read_b64_tr_b16 v[78:79], v4 offset:7168
    s_barrier
    s_waitcnt lgkmcnt(11)
    v_mfma_f32_32x32x16_bf16 v[16:31], v[80:83], v[128:131], v[16:31]
    ds_read_b128 v[128:131], v148 offset:0
    v_lshlrev_b32 v112, 16, v160
    v_and_b32 v113, 0xffff0000, v160
    v_lshlrev_b32 v114, 16, v161
    s_waitcnt lgkmcnt(9)
    v_mfma_f32_32x32x16_bf16 v[16:31], v[84:87], v[132:135], v[16:31]
    ds_read_b128 v[132:135], v148 offset:2048
    v_and_b32 v115, 0xffff0000, v161
    v_lshlrev_b32 v116, 16, v162
    v_and_b32 v117, 0xffff0000, v162
    s_waitcnt lgkmcnt(7)
    v_mfma_f32_32x32x16_bf16 v[16:31], v[88:91], v[136:139], v[16:31]
    ds_read_b128 v[136:139], v148 offset:4096
    v_lshlrev_b32 v118, 16, v163
    v_and_b32 v119, 0xffff0000, v163
    v_lshlrev_b32 v120, 16, v164
    s_waitcnt lgkmcnt(5)
    v_mfma_f32_32x32x16_bf16 v[16:31], v[92:95], v[140:143], v[16:31]
    ds_read_b128 v[140:143], v148 offset:6144
    v_and_b32 v121, 0xffff0000, v164
    v_lshlrev_b32 v122, 16, v165
    v_and_b32 v123, 0xffff0000, v165
    s_waitcnt lgkmcnt(3)
    v_mfma_f32_32x32x16_bf16 v[16:31], v[96:99], v[128:131], v[16:31]
    ds_read_b128 v[128:131], v149 offset:0
    v_lshlrev_b32 v124, 16, v166
    v_and_b32 v125, 0xffff0000, v166
    v_lshlrev_b32 v126, 16, v167
    s_waitcnt lgkmcnt(3)
    v_mfma_f32_32x32x16_bf16 v[16:31], v[100:103], v[132:135], v[16:31]
    ds_read_b128 v[132:135], v149 offset:2048
    v_and_b32 v127, 0xffff0000, v167
    v_fma_f32 v112, -v112, v10, v112
    v_fma_f32 v113, -v113, v10, v113
    s_waitcnt lgkmcnt(3)
    v_mfma_f32_32x32x16_bf16 v[16:31], v[104:107], v[136:139], v[16:31]
    ds_read_b128 v[136:139], v149 offset:4096
    v_fma_f32 v114, -v114, v10, v114
    v_fma_f32 v115, -v115, v10, v115
    v_fma_f32 v116, -v116, v10, v116
    s_waitcnt lgkmcnt(3)
    v_mfma_f32_32x32x16_bf16 v[16:31], v[108:111], v[140:143], v[16:31]
    ds_read_b128 v[140:143], v149 offset:6144
    v_fma_f32 v117, -v117, v10, v117
    v_fma_f32 v118, -v118, v10, v118
    v_fma_f32 v119, -v119, v10, v119
    s_barrier
    s_waitcnt lgkmcnt(3)
    v_mfma_f32_32x32x16_bf16 v[16:31], v[32:35], v[128:131], v[16:31]
    ds_read_b128 v[128:131], v150 offset:0
    v_fma_f32 v120, -v120, v10, v120
    v_fma_f32 v121, -v121, v10, v121
    v_fma_f32 v122, -v122, v10, v122
    s_waitcnt lgkmcnt(3)
    v_mfma_f32_32x32x16_bf16 v[16:31], v[36:39], v[132:135], v[16:31]
    ds_read_b128 v[132:135], v150 offset:2048
    v_fma_f32 v123, -v123, v10, v123
    v_fma_f32 v124, -v124, v10, v124
    v_fma_f32 v125, -v125, v10, v125
    s_waitcnt lgkmcnt(3)
    v_mfma_f32_32x32x16_bf16 v[16:31], v[40:43], v[136:139], v[16:31]
    ds_read_b128 v[136:139], v150 offset:4096
    v_fma_f32 v126, -v126, v10, v126
    v_fma_f32 v127, -v127, v10, v127
    v_and_b32 v5, 31, v1
    s_waitcnt lgkmcnt(3)
    v_mfma_f32_32x32x16_bf16 v[16:31], v[44:47], v[140:143], v[16:31]
    ds_read_b128 v[140:143], v150 offset:6144
    v_lshrrev_b32 v11, 5, v1
    v_bfe_u32 v14, v1, 1, 2
    v_lshlrev_b32 v11, 1, v11
    s_waitcnt lgkmcnt(3)
    v_mfma_f32_32x32x16_bf16 v[16:31], v[48:51], v[128:131], v[16:31]
    ds_read_b128 v[128:131], v151 offset:0
    v_xor_b32 v11, v11, v14
    v_lshlrev_b32 v11, 4, v11
    v_lshl_add_u32 v11, v5, 6, v11
    s_waitcnt lgkmcnt(3)
    v_mfma_f32_32x32x16_bf16 v[16:31], v[52:55], v[132:135], v[16:31]
    ds_read_b128 v[132:135], v151 offset:2048
    v_add_u32 v152, s48, v11
    v_xor_b32 v153, 16, v152
    v_bfe_u32 v14, v1, 3, 2
    s_waitcnt lgkmcnt(3)
    v_mfma_f32_32x32x16_bf16 v[16:31], v[56:59], v[136:139], v[16:31]
    ds_read_b128 v[136:139], v151 offset:4096
    v_lshlrev_b32 v14, 4, v14
    v_xor_b32 v14, v14, v15
    v_add_u32 v154, s48, v14
    s_waitcnt lgkmcnt(3)
    v_mfma_f32_32x32x16_bf16 v[16:31], v[60:63], v[140:143], v[16:31]
    ds_read_b128 v[140:143], v151 offset:6144
    v_lshrrev_b32 v5, 2, v1
    v_and_b32 v11, 3, v1
    v_lshlrev_b32 v11, 4, v11
    s_waitcnt lgkmcnt(3)
    v_mfma_f32_32x32x16_bf16 v[16:31], v[64:67], v[128:131], v[16:31]
    v_lshl_add_u32 v159, v5, 10, v11
    s_and_b32 s28, s20, 1
    s_lshl_b32 s28, s28, 15
    s_waitcnt lgkmcnt(2)
    v_mfma_f32_32x32x16_bf16 v[16:31], v[68:71], v[132:135], v[16:31]
    s_add_u32 s64, s64, s28
    s_add_u32 s28, s64, 16384
    s_lshl_b32 s29, s68, 6
    s_waitcnt lgkmcnt(1)
    v_mfma_f32_32x32x16_bf16 v[16:31], v[72:75], v[136:139], v[16:31]
    v_add_u32 v13, s29, v158
    v_not_b32 v13, v13
    v_cmp_eq_u32 s[32:33], v13, v6
    s_waitcnt lgkmcnt(0)
    v_mfma_f32_32x32x16_bf16 v[16:31], v[76:79], v[140:143], v[16:31]
    s_cmp_lg_u64 s[32:33], 0
    s_cbranch_scc1 L_moerow
L_nomoe:
    s_nop 9
    v_cmp_u_f32 vcc, v16, v16
    s_cbranch_vccnz L_slow3
L_epi:
    v_pk_fma_f32 v[112:113], v[16:17], v[10:11], v[112:113] op_sel_hi:[1,0,1]
    v_pk_fma_f32 v[114:115], v[18:19], v[10:11], v[114:115] op_sel_hi:[1,0,1]
    v_pk_fma_f32 v[116:117], v[20:21], v[10:11], v[116:117] op_sel_hi:[1,0,1]
    v_pk_fma_f32 v[118:119], v[22:23], v[10:11], v[118:119] op_sel_hi:[1,0,1]
    v_pk_fma_f32 v[120:121], v[24:25], v[10:11], v[120:121] op_sel_hi:[1,0,1]
    v_pk_fma_f32 v[122:123], v[26:27], v[10:11], v[122:123] op_sel_hi:[1,0,1]
    v_pk_fma_f32 v[124:125], v[28:29], v[10:11], v[124:125] op_sel_hi:[1,0,1]
    v_pk_fma_f32 v[126:127], v[30:31], v[10:11], v[126:127] op_sel_hi:[1,0,1]
    v_cvt_pk_bf16_f32 v16, v112, v113
    v_cvt_pk_bf16_f32 v17, v114, v115
    v_cvt_pk_bf16_f32 v18, v116, v117
    v_cvt_pk_bf16_f32 v19, v118, v119
    ds_write_b128 v152, v[16:19]
    v_cvt_pk_bf16_f32 v20, v120, v121
    v_cvt_pk_bf16_f32 v21, v122, v123
    v_cvt_pk_bf16_f32 v22, v124, v125
    v_cvt_pk_bf16_f32 v23, v126, v127
    ds_write_b128 v153, v[20:23]
    ds_read_b128 v[24:27], v154
    ds_read_b128 v[28:31], v154 offset:1024
    s_waitcnt lgkmcnt(1)
    buffer_store_dwordx4 v[24:27], v159, s[16:19], s64 offen
    s_waitcnt lgkmcnt(0)
    buffer_store_dwordx4 v[28:31], v159, s[16:19], s28 offen
    s_endpgm
L_slow3:
    s_mul_i32 s30, s68, 4352
    s_add_u32 s30, s30, 0x8c8800
    v_mov_b32 v2, 0
    s_mov_b64 exec, 1
    s_mov_b32 s61, 0
L_ps:
    buffer_load_dword v3, v2, s[12:15], s30 offen offset:8 sc1
    s_add_u32 s61, s61, 1
    s_cmp_gt_u32 s61, 131072
    s_cbranch_scc1 L_ps_x
    s_waitcnt vmcnt(0)
    v_cmp_ne_u32 vcc, 0xff, v3
    s_cbranch_vccz L_ps_x
    s_sleep 4
    s_branch L_ps
L_ps_x:
    s_waitcnt vmcnt(0)
    s_mov_b64 exec, -1
    s_lshl_b32 s30, s68, 16
    s_and_b32 s31, s20, 1
    s_lshl_b32 s31, s31, 15
    s_add_u32 s30, s30, s31
    s_add_u32 s30, s30, 0x600000
    s_mov_b32 s31, 8
    v_mov_b32 v2, v156
    v_mov_b32 v16, 0
    v_mov_b32 v17, 0
    v_mov_b32 v18, 0
    v_mov_b32 v19, 0
    v_mov_b32 v20, 0
    v_mov_b32 v21, 0
    v_mov_b32 v22, 0
    v_mov_b32 v23, 0
    v_mov_b32 v24, 0
    v_mov_b32 v25, 0
    v_mov_b32 v26, 0
    v_mov_b32 v27, 0
    v_mov_b32 v28, 0
    v_mov_b32 v29, 0
    v_mov_b32 v30, 0
    v_mov_b32 v31, 0
L_slow3l:
    buffer_load_dwordx4 v[128:131], v15, s[12:15], s30 offen offset:0 sc1
    ds_read_b64_tr_b16 v[32:33], v2 offset:0
    ds_read_b64_tr_b16 v[34:35], v2 offset:1024
    buffer_load_dwordx4 v[132:135], v15, s[12:15], s30 offen offset:1024 sc1
    ds_read_b64_tr_b16 v[36:37], v2 offset:2048
    ds_read_b64_tr_b16 v[38:39], v2 offset:3072
    buffer_load_dwordx4 v[136:139], v15, s[12:15], s30 offen offset:2048 sc1
    ds_read_b64_tr_b16 v[40:41], v2 offset:4096
    ds_read_b64_tr_b16 v[42:43], v2 offset:5120
    buffer_load_dwordx4 v[140:143], v15, s[12:15], s30 offen offset:3072 sc1
    ds_read_b64_tr_b16 v[44:45], v2 offset:6144
    ds_read_b64_tr_b16 v[46:47], v2 offset:7168
    s_add_u32 s30, s30, 4096
    s_sub_u32 s31, s31, 1
    s_waitcnt vmcnt(0) lgkmcnt(0)
    v_add_u32 v2, 8192, v2
    v_mfma_f32_32x32x16_bf16 v[16:31], v[32:35], v[128:131], v[16:31]
    v_mfma_f32_32x32x16_bf16 v[16:31], v[36:39], v[132:135], v[16:31]
    v_mfma_f32_32x32x16_bf16 v[16:31], v[40:43], v[136:139], v[16:31]
    v_mfma_f32_32x32x16_bf16 v[16:31], v[44:47], v[140:143], v[16:31]
    s_cmp_lg_u32 s31, 0
    s_cbranch_scc1 L_slow3l
    s_nop 11
    s_branch L_epi
L_moerow:
    v_lshrrev_b32 v3, 5, v1
    v_lshl_add_u32 v12, v3, 6, v12
    v_add_u32 v12, s65, v12
    ds_read_b128 v[80:83], v12 offset:256
    ds_read_b128 v[84:87], v12 offset:272
    ds_read_b128 v[88:91], v12 offset:288
    ds_read_b128 v[92:95], v12 offset:304
    v_not_b32 v13, v7
    v_ashrrev_i32 v13, 31, v13
    v_or_b32 v13, 0x80000000, v13
    v_xor_b32 v13, v13, v7
    v_mul_f32 v13, 0xbfb8aa3b, v13
    v_exp_f32 v13, v13
    s_nop 0
    v_add_f32 v13, 1.0, v13
    v_rcp_f32 v13, v13
    s_nop 0
    v_fma_f32 v13, -v13, v10, v13
    s_mov_b64 exec, s[32:33]
    s_waitcnt lgkmcnt(0)
    v_fmac_f32 v112, v13, v80
    v_fmac_f32 v113, v13, v81
    v_fmac_f32 v114, v13, v82
    v_fmac_f32 v115, v13, v83
    v_fmac_f32 v116, v13, v84
    v_fmac_f32 v117, v13, v85
    v_fmac_f32 v118, v13, v86
    v_fmac_f32 v119, v13, v87
    v_fmac_f32 v120, v13, v88
    v_fmac_f32 v121, v13, v89
    v_fmac_f32 v122, v13, v90
    v_fmac_f32 v123, v13, v91
    v_fmac_f32 v124, v13, v92
    v_fmac_f32 v125, v13, v93
    v_fmac_f32 v126, v13, v94
    v_fmac_f32 v127, v13, v95
    s_mov_b64 exec, -1
    s_branch L_nomoe
L_fallback:
    s_lshr_b32 s30, s20, 2
    s_lshl_b32 s30, s30, 11
    s_sub_u32 s8, s8, s30
    s_subb_u32 s9, s9, 0
    s_mov_b32 s30, 0
    v_mov_b32 v2, 0xff800000
L_fb1:
    buffer_load_dwordx4 v[88:91], v149, s[8:11], s30 offen sc1
    s_waitcnt vmcnt(0)
    v_mfma_f32_32x32x16_bf16 v[16:31], v[88:91], v[84:87], 0
    s_add_u32 s30, s30, 2048
    s_nop 11
    v_max3_f32 v2, v2, v16, v17
    v_max3_f32 v2, v2, v18, v19
    v_max3_f32 v2, v2, v20, v21
    v_max3_f32 v2, v2, v22, v23
    v_max3_f32 v2, v2, v24, v25
    v_max3_f32 v2, v2, v26, v27
    v_max3_f32 v2, v2, v28, v29
    v_max3_f32 v2, v2, v30, v31
    s_cmp_lt_u32 s30, 0x20000
    s_cbranch_scc1 L_fb1
    v_mov_b32 v3, v2
    s_nop 1
    v_permlane32_swap_b32 v2, v3
    s_nop 1
    v_max_f32 v2, v2, v3
    v_sub_f32 v48, 0, v2
    v_sub_f32 v49, 0, v2
    v_sub_f32 v50, 0, v2
    v_sub_f32 v51, 0, v2
    v_sub_f32 v52, 0, v2
    v_sub_f32 v53, 0, v2
    v_sub_f32 v54, 0, v2
    v_sub_f32 v55, 0, v2
    v_sub_f32 v56, 0, v2
    v_sub_f32 v57, 0, v2
    v_sub_f32 v58, 0, v2
    v_sub_f32 v59, 0, v2
    v_sub_f32 v60, 0, v2
    v_sub_f32 v61, 0, v2
    v_sub_f32 v62, 0, v2
    v_sub_f32 v63, 0, v2
    v_mov_b32 v64, 0
    v_mov_b32 v65, 0
    v_mov_b32 v66, 0
    v_mov_b32 v67, 0
    v_mov_b32 v68, 0
    v_mov_b32 v69, 0
    v_mov_b32 v70, 0
    v_mov_b32 v71, 0
    v_mov_b32 v72, 0
    v_mov_b32 v73, 0
    v_mov_b32 v74, 0
    v_mov_b32 v75, 0
    v_mov_b32 v76, 0
    v_mov_b32 v77, 0
    v_mov_b32 v78, 0
    v_mov_b32 v79, 0
    s_mov_b32 s30, 0
L_fb2:
    buffer_load_dwordx4 v[88:91], v149, s[8:11], s30 offen sc1
    s_mov_b64 exec, s[52:53]
    buffer_load_dwordx4 v[112:115], v148, s[8:11], s30 offen offset:1024 sc1
    buffer_load_dwordx4 v[116:119], v148, s[8:11], s30 offen offset:1536 sc1
    s_mov_b64 exec, -1
    s_waitcnt vmcnt(0)
    v_mfma_f32_32x32x16_bf16 v[16:31], v[88:91], v[84:87], v[48:63]
    s_add_u32 s30, s30, 2048
    s_nop 11
    v_exp_f32 v16, v16
    v_exp_f32 v17, v17
    v_exp_f32 v18, v18
    v_exp_f32 v19, v19
    v_exp_f32 v20, v20
    v_exp_f32 v21, v21
    v_exp_f32 v22, v22
    v_exp_f32 v23, v23
    v_exp_f32 v24, v24
    v_exp_f32 v25, v25
    v_exp_f32 v26, v26
    v_exp_f32 v27, v27
    v_exp_f32 v28, v28
    v_exp_f32 v29, v29
    v_exp_f32 v30, v30
    v_exp_f32 v31, v31
    s_nop 1
    v_smfmac_f32_32x32x32_bf16 v[64:79], v[112:115], v[16:23], v147
    v_smfmac_f32_32x32x32_bf16 v[64:79], v[116:119], v[24:31], v147
    s_cmp_lt_u32 s30, 0x20000
    s_cbranch_scc1 L_fb2
    s_nop 15
    v_rcp_f32 v2, v72
    s_nop 0
    v_mul_f32 v16, v2, v64
    v_mul_f32 v17, v2, v65
    v_mul_f32 v18, v2, v66
    v_mul_f32 v19, v2, v67
    v_mul_f32 v20, v2, v68
    v_mul_f32 v21, v2, v69
    v_mul_f32 v22, v2, v70
    v_mul_f32 v23, v2, v71
    v_cvt_pk_bf16_f32 v4, v16, v17
    v_cvt_pk_bf16_f32 v5, v18, v19
    v_cvt_pk_bf16_f32 v6, v20, v21
    v_cvt_pk_bf16_f32 v7, v22, v23
    s_branch L_fin
L_help:
    s_waitcnt lgkmcnt(0)
    s_mov_b32 s4, s36
    s_mov_b32 s5, s37
    s_mov_b32 s6, 0x200000
    s_mov_b32 s7, 0x20000
    s_mov_b32 s12, s58
    s_mov_b32 s13, s59
    s_mov_b32 s14, 0x920000
    s_mov_b32 s15, 0x20000
    s_mov_b32 s8, s44
    s_mov_b32 s9, s45
    s_mov_b32 s10, 0x400
    s_mov_b32 s11, 0x20000
    s_mov_b32 s16, s52
    s_mov_b32 s17, s53
    s_mov_b32 s18, 0x400
    s_mov_b32 s19, 0x20000
    s_lshl_b32 s24, s22, 3
    s_mov_b32 m0, 158720
    s_add_u32 s24, s24, s21
    buffer_load_dwordx4 v15, s[8:11], 0 offen lds
    s_mov_b32 m0, 159744
    s_nop 0
    buffer_load_dwordx4 v15, s[16:19], 0 offen lds
    s_add_u32 s62, s58, 0x808000
    s_addc_u32 s63, s59, 0
    s_load_dword s60, s[62:63], 0
    v_mov_b32 v56, 0
    v_lshlrev_b32 v61, 2, v1
    v_mul_u32_u24 v62, 4352, v1
    v_lshrrev_b32 v2, 3, v1
    v_and_b32 v3, 7, v1
    v_lshlrev_b32 v4, 4, v3
    v_mul_u32_u24 v14, 2752, v2
    v_add_u32 v14, v14, v4
    v_lshl_add_u32 v58, v2, 10, v4
    v_bfe_u32 v4, v1, 4, 1
    v_lshlrev_b32 v4, 6, v4
    v_xor_b32 v59, v58, v4
    v_lshrrev_b32 v2, 4, v1
    v_bfe_u32 v3, v1, 2, 2
    v_and_b32 v4, 3, v1
    v_lshl_add_u32 v5, v2, 3, v3
    v_lshlrev_b32 v5, 7, v5
    v_lshl_add_u32 v5, v4, 3, v5
    v_add_u32 v60, 65536, v5
    v_lshlrev_b32 v2, 4, v2
    v_bfrev_b32 v4, 1
    v_cmp_eq_u32 vcc, 0, v3
    s_nop 1
    v_cndmask_b32 v6, v4, v2, vcc
    v_min_u32 v10, 128, v6
    v_add_u32 v10, 158208, v10
    v_cmp_eq_u32 vcc, 1, v3
    s_nop 1
    v_cndmask_b32 v7, v4, v2, vcc
    v_min_u32 v11, 128, v7
    v_add_u32 v11, 158208, v11
    v_cmp_eq_u32 vcc, 2, v3
    s_nop 1
    v_cndmask_b32 v8, v4, v2, vcc
    v_min_u32 v12, 128, v8
    v_add_u32 v12, 158208, v12
    v_cmp_eq_u32 vcc, 3, v3
    s_nop 1
    v_cndmask_b32 v9, v4, v2, vcc
    v_min_u32 v13, 128, v9
    v_add_u32 v13, 158208, v13
    v_add_u32 v160, 157696, v61
    v_mov_b32 v161, 157696
    v_lshlrev_b32 v162, 1, v1
    v_add_u32 v162, 158208, v162
    s_lshr_b32 s64, s2, 3
    s_and_b32 s65, s2, 7
    s_lshl_b32 s25, 1, s65
    s_lshl_b32 s26, 1, s64
    s_lshl_b32 s27, 1, s21
    v_mov_b32 v163, s25
    v_mov_b32 v164, s26
    v_mov_b32 v165, s27
    v_mov_b32 v166, 0
    v_mov_b32 v167, -1
    v_mov_b32 v152, -1
    v_mov_b32 v153, -1
    v_mov_b32 v154, -1
    v_mov_b32 v155, -1
    v_mov_b32 v156, 0
    ds_write_b32 v160, v56 offset:0
    ds_write_b32 v160, v56 offset:256
    ds_write_b32 v160, v56 offset:512
    s_waitcnt lgkmcnt(0)
    s_mul_i32 s60, s60, 0x9E3779B1
    s_add_u32 s60, s60, 0x7F4A7C15
    s_mul_i32 s34, s21, 4352
    s_add_u32 s34, s34, 0x8c0000
    s_mul_i32 s35, s22, 4352
    s_add_u32 s35, s35, 0x8c8800
    s_cmp_lg_u32 s2, 0
    s_cbranch_scc1 L_nl1
    v_mov_b32 v64, 0
    v_mov_b32 v65, s60
    v_mov_b32 v66, 0
    v_mov_b32 v67, 0
    s_mov_b32 s25, 0x8c8800
    buffer_store_dwordx4 v[64:67], v62, s[12:15], s25 offen sc1
    s_mov_b64 exec, 0xff
    buffer_store_dwordx4 v[64:67], v62, s[12:15], s34 offen offset:2048 sc1
    s_waitcnt vmcnt(0)
    buffer_store_dwordx4 v[64:67], v62, s[12:15], s34 offen sc1
    s_mov_b64 exec, -1
L_nl1:
    v_lshrrev_b32 v2, 3, v1
    s_lshl_b32 s25, s21, 3
    v_add_u32 v3, s25, v2
    v_lshlrev_b32 v30, 2, v2
    s_lshl_b32 s25, s24, 3
    v_add_u32 v31, s25, v2
    v_bfe_u32 v4, v3, 1, 3
    v_and_b32 v5, 7, v1
    v_xor_b32 v4, v4, v5
    v_lshlrev_b32 v4, 4, v4
    v_lshl_add_u32 v28, v3, 7, v4
    v_lshlrev_b32 v5, 4, v5
    v_add_u32 v29, 158720, v5
    v_mov_b32 v4, 0
    v_mov_b32 v5, 0
    s_mov_b32 s25, 0
    s_barrier
    s_waitcnt vmcnt(0)
L_hd:
    s_add_u32 s26, s25, s23
    s_and_b32 s26, s26, 7
    s_lshl_b32 s26, s26, 7
    v_add_u32 v2, s26, v29
    ds_read_b128 v[20:23], v2
    ds_read_b128 v[24:27], v2 offset:1024
    ds_read_b128 v[16:19], v28
    v_add_u32 v28, 8192, v28
    s_barrier
    s_cmp_lg_u32 s25, 5
    s_cbranch_scc1 L_hd1
    s_mov_b64 exec, 1
    buffer_load_dword v63, v56, s[12:15], s34 offen offset:4 sc1
    s_mov_b64 exec, -1
L_hd1:
    s_add_u32 s25, s25, 1
    s_waitcnt lgkmcnt(0)
    v_dot2c_f32_bf16 v4, v16, v20
    v_dot2c_f32_bf16 v5, v16, v24
    v_dot2c_f32_bf16 v4, v17, v21
    v_dot2c_f32_bf16 v5, v17, v25
    v_dot2c_f32_bf16 v4, v18, v22
    v_dot2c_f32_bf16 v5, v18, v26
    v_dot2c_f32_bf16 v4, v19, v23
    v_dot2c_f32_bf16 v5, v19, v27
    s_cmp_lt_u32 s25, 8
    s_cbranch_scc1 L_hd
    s_setprio 3
    s_mov_b64 exec, 1
    s_waitcnt vmcnt(0)
    v_cmp_ne_u32 vcc, s60, v63
    s_cbranch_vccz L_pv_x
    s_mov_b32 s61, 0
L_pv:
    buffer_load_dword v63, v56, s[12:15], s34 offen offset:4 sc1
    s_add_u32 s61, s61, 1
    s_cmp_gt_u32 s61, 131072
    s_cbranch_scc1 L_pv_x
    s_waitcnt vmcnt(0)
    v_cmp_ne_u32 vcc, s60, v63
    s_cbranch_vccz L_pv_x
    s_branch L_pv
L_pv_x:
    s_waitcnt vmcnt(0)
    s_mov_b64 exec, -1
    v_add_f32_dpp v4, v4, v4 row_shr:1 row_mask:0xf bank_mask:0xf
    v_add_f32_dpp v5, v5, v5 row_shr:1 row_mask:0xf bank_mask:0xf
    s_nop 0
    v_add_f32_dpp v4, v4, v4 row_shr:2 row_mask:0xf bank_mask:0xf
    v_add_f32_dpp v5, v5, v5 row_shr:2 row_mask:0xf bank_mask:0xf
    s_nop 0
    v_add_f32_dpp v4, v4, v4 row_shr:4 row_mask:0xf bank_mask:0xf
    v_add_f32_dpp v5, v5, v5 row_shr:4 row_mask:0xf bank_mask:0xf
    s_nop 0
    v_mul_f32 v5, 0xbfb8aa3b, v5
    v_exp_f32 v5, v5
    v_ashrrev_i32 v2, 31, v4
    v_add_f32 v5, 1.0, v5
    v_rcp_f32 v16, v5
    v_or_b32 v2, 0x80000000, v2
    v_xor_b32 v19, v2, v4
    v_not_b32 v18, v31
    s_mov_b32 s28, 0x80808080
    s_mov_b32 s29, 0x80808080
    s_mov_b64 exec, s[28:29]
    ds_max_u64 v161, v[18:19] offset:8
    s_mov_b64 exec, 1
    ds_read_b64 v[18:19], v161 offset:8
    s_lshl_b32 s26, s24, 5
    s_add_u32 s26, s26, 0x802000
    s_lshl_b32 s25, 1, s22
    v_mov_b32 v57, s25
    v_mov_b32 v5, s60
    v_mov_b32 v20, s25
    s_waitcnt lgkmcnt(0)
    s_barrier
    s_barrier
    buffer_atomic_or v20, v56, s[12:15], s34 offen sc0
    s_barrier
    s_waitcnt vmcnt(0)
    v_or_b32 v63, v20, v57
    v_bcnt_u32_b32 v2, v63, 0
    v_cmp_gt_u32 vcc, 7, v2
    s_cbranch_vccz L_p1_y
    s_mov_b32 s61, 0
L_p1:
    buffer_atomic_or v63, v56, s[12:15], s34 offen sc0
    s_add_u32 s61, s61, 1
    s_cmp_gt_u32 s61, 131072
    s_cbranch_scc1 L_p1_x
    s_waitcnt vmcnt(0)
    v_bcnt_u32_b32 v2, v63, 0
    v_cmp_gt_u32 vcc, 7, v2
    s_cbranch_vccz L_p1_x
    s_branch L_p1
L_p1_x:
    s_waitcnt vmcnt(0)
L_p1_y:
    ds_write_b32 v161, v63 offset:16
    v_cmp_ne_u32 vcc, -1, v63
    s_waitcnt lgkmcnt(0)
    s_barrier
    s_mov_b64 exec, s[28:29]
    buffer_store_dword v16, v30, s[12:15], s26 offen sc1
    s_mov_b64 exec, 1
    buffer_atomic_umax_x2 v[18:19], v56, s[12:15], s34 offen offset:2056
    s_cbranch_vccz L_pf_x
    s_sleep 10
    s_mov_b32 s61, 0
L_pf:
    buffer_atomic_or v63, v56, s[12:15], s34 offen sc0
    s_add_u32 s61, s61, 1
    s_cmp_gt_u32 s61, 131072
    s_cbranch_scc1 L_pf_x
    s_waitcnt vmcnt(0)
    v_cmp_ne_u32 vcc, -1, v63
    s_cbranch_vccz L_pf_x
    s_sleep 4
    s_branch L_pf
L_pf_x:
    s_waitcnt vmcnt(0)
    ds_write_b32 v161, v167 offset:16
    buffer_atomic_or v57, v56, s[12:15], s34 offen offset:2048
    s_mov_b64 exec, -1
    s_setprio 0
    s_mov_b32 s16, s40
    s_mov_b32 s17, s41
    s_mov_b32 s18, 0x80000
    s_mov_b32 s19, 0x20000
    s_lshl_b32 s30, s68, 14
    s_and_b32 s30, s30, 0xffff
    s_mov_b32 s31, 0
    s_lshl_b32 s100, s69, 7
    s_cmp_ge_u32 s2, 176
    s_cbranch_scc1 L_a0
    s_mul_i32 s66, s65, 176128
    s_lshl_b32 s27, s64, 7
    s_add_u32 s66, s66, s27
    s_mov_b32 s99, s66
    s_mov_b32 s8, s46
    s_mov_b32 s9, s47
    s_mov_b32 s10, 0x158000
    s_mov_b32 s11, 0x20000
    s_mov_b32 s29, 65536
L_stg:
    s_mov_b32 m0, s29
    s_add_u32 s29, s29, 1024
    buffer_load_dwordx4 v14, s[8:11], s99 offen lds
    s_add_u32 s99, s99, 22016
    s_waitcnt vmcnt(2)
    s_cmp_lt_u32 s29, 73728
    s_cbranch_scc1 L_stg
    s_mov_b32 s99, s66
    s_mov_b32 s8, s48
    s_mov_b32 s9, s49
    s_mov_b32 s10, 0x158000
    s_mov_b32 s11, 0x20000
    s_mov_b32 s29, 73728
L_stu:
    s_mov_b32 m0, s29
    s_add_u32 s29, s29, 1024
    buffer_load_dwordx4 v14, s[8:11], s99 offen lds
    s_add_u32 s99, s99, 22016
    s_waitcnt vmcnt(2)
    s_cmp_lt_u32 s29, 81920
    s_cbranch_scc1 L_stu
    s_branch L_a1
L_a0:
    s_mov_b32 s33, 24
L_won:
    s_mov_b32 m0, s30
    s_lshl_b32 s32, s30, 3
    s_add_u32 s32, s32, s100
    buffer_load_dwordx4 v59, s[16:19], s32 offen offset:0 lds
    s_add_u32 s32, s32, 7168
    s_waitcnt vmcnt(2)
    buffer_load_dwordx4 v59, s[16:19], s32 offen offset:1024 lds
    s_add_u32 s32, s32, 7168
    s_waitcnt vmcnt(2)
    buffer_load_dwordx4 v59, s[16:19], s32 offen offset:2048 lds
    s_add_u32 s32, s32, 7168
    s_waitcnt vmcnt(2)
    buffer_load_dwordx4 v59, s[16:19], s32 offen offset:3072 lds
    s_waitcnt vmcnt(2)
    s_add_u32 s30, s30, 4096
    s_and_b32 s30, s30, 0xffff
    s_add_u32 s31, s31, 4
    s_cmp_lt_u32 s31, s33
    s_cbranch_scc1 L_won
L_a1:
    s_mov_b32 s25, 0x8c0000
    s_mov_b64 exec, 0xff
    s_mov_b32 s61, 0
L_pa:
    buffer_load_dwordx4 v[16:19], v62, s[12:15], s25 offen offset:2048 sc1
    s_add_u32 s61, s61, 1
    s_cmp_gt_u32 s61, 131072
    s_cbranch_scc1 L_pa_x
    s_waitcnt vmcnt(0)
    s_setprio 3
    v_cmp_ne_u32 vcc, -1, v16
    s_setprio 0
    s_cbranch_vccz L_pa_x
    s_sleep 16
    s_branch L_pa
L_pa_x:
    s_waitcnt vmcnt(0)
    ds_max_u64 v161, v[18:19]
    s_mov_b64 exec, 1
    ds_read_b32 v2, v161
    s_cmp_lg_u32 s2, 0
    s_cbranch_scc1 L_noep
    s_mov_b32 s27, 0x808000
    buffer_store_dword v5, v56, s[12:15], s27 offen
L_noep:
    s_setprio 3
    s_waitcnt lgkmcnt(0)
    v_readfirstlane_b32 s63, v2
    s_mov_b64 exec, -1
    s_setprio 0
    s_nop 1
    s_not_b32 s63, s63
    s_min_u32 s63, s63, 2047
    s_cmp_ge_u32 s2, 176
    s_cbranch_scc1 L_worest
    s_lshl_b32 s27, s63, 10
    s_lshl_b32 s28, s65, 7
    s_add_u32 s27, s27, s28
    buffer_load_dwordx4 v[16:19], v6, s[4:7], s27 offen offset:0
    buffer_load_dwordx4 v[20:23], v7, s[4:7], s27 offen offset:0
    buffer_load_dwordx4 v[24:27], v8, s[4:7], s27 offen offset:0
    buffer_load_dwordx4 v[28:31], v9, s[4:7], s27 offen offset:0
    buffer_load_dwordx4 v[32:35], v6, s[4:7], s27 offen offset:64
    buffer_load_dwordx4 v[36:39], v7, s[4:7], s27 offen offset:64
    buffer_load_dwordx4 v[40:43], v8, s[4:7], s27 offen offset:64
    buffer_load_dwordx4 v[44:47], v9, s[4:7], s27 offen offset:64
    ds_read_b64_tr_b16 v[64:65], v60 offset:0
    ds_read_b64_tr_b16 v[66:67], v60 offset:512
    ds_read_b64_tr_b16 v[68:69], v60 offset:32
    ds_read_b64_tr_b16 v[70:71], v60 offset:544
    ds_read_b64_tr_b16 v[72:73], v60 offset:64
    ds_read_b64_tr_b16 v[74:75], v60 offset:576
    ds_read_b64_tr_b16 v[76:77], v60 offset:96
    ds_read_b64_tr_b16 v[78:79], v60 offset:608
    ds_read_b64_tr_b16 v[80:81], v60 offset:4096
    ds_read_b64_tr_b16 v[82:83], v60 offset:4608
    ds_read_b64_tr_b16 v[84:85], v60 offset:4128
    ds_read_b64_tr_b16 v[86:87], v60 offset:4640
    ds_read_b64_tr_b16 v[88:89], v60 offset:4160
    ds_read_b64_tr_b16 v[90:91], v60 offset:4672
    s_waitcnt lgkmcnt(8)
    ds_read_b64_tr_b16 v[92:93], v60 offset:4192
    ds_read_b64_tr_b16 v[94:95], v60 offset:4704
    s_waitcnt lgkmcnt(0)
    ds_read_b64_tr_b16 v[96:97], v60 offset:8192
    ds_read_b64_tr_b16 v[98:99], v60 offset:8704
    ds_read_b64_tr_b16 v[100:101], v60 offset:8224
    ds_read_b64_tr_b16 v[102:103], v60 offset:8736
    ds_read_b64_tr_b16 v[104:105], v60 offset:8256
    ds_read_b64_tr_b16 v[106:107], v60 offset:8768
    ds_read_b64_tr_b16 v[108:109], v60 offset:8288
    ds_read_b64_tr_b16 v[110:111], v60 offset:8800
    ds_read_b64_tr_b16 v[112:113], v60 offset:12288
    ds_read_b64_tr_b16 v[114:115], v60 offset:12800
    ds_read_b64_tr_b16 v[116:117], v60 offset:12320
    ds_read_b64_tr_b16 v[118:119], v60 offset:12832
    ds_read_b64_tr_b16 v[120:121], v60 offset:12352
    ds_read_b64_tr_b16 v[122:123], v60 offset:12864
    s_waitcnt lgkmcnt(8)
    ds_read_b64_tr_b16 v[124:125], v60 offset:12384
    ds_read_b64_tr_b16 v[126:127], v60 offset:12896
    s_waitcnt lgkmcnt(0)
    s_waitcnt vmcnt(0)
    v_mfma_f32_16x16x32_bf16 v[48:51], v[16:19], v[64:67], 0
    v_mfma_f32_16x16x32_bf16 v[52:55], v[16:19], v[96:99], 0
    v_mfma_f32_16x16x32_bf16 v[48:51], v[20:23], v[68:71], v[48:51]
    v_mfma_f32_16x16x32_bf16 v[52:55], v[20:23], v[100:103], v[52:55]
    v_mfma_f32_16x16x32_bf16 v[48:51], v[24:27], v[72:75], v[48:51]
    v_mfma_f32_16x16x32_bf16 v[52:55], v[24:27], v[104:107], v[52:55]
    v_mfma_f32_16x16x32_bf16 v[48:51], v[28:31], v[76:79], v[48:51]
    v_mfma_f32_16x16x32_bf16 v[52:55], v[28:31], v[108:111], v[52:55]
    v_mfma_f32_16x16x32_bf16 v[48:51], v[32:35], v[80:83], v[48:51]
    v_mfma_f32_16x16x32_bf16 v[52:55], v[32:35], v[112:115], v[52:55]
    v_mfma_f32_16x16x32_bf16 v[48:51], v[36:39], v[84:87], v[48:51]
    v_mfma_f32_16x16x32_bf16 v[52:55], v[36:39], v[116:119], v[52:55]
    v_mfma_f32_16x16x32_bf16 v[48:51], v[40:43], v[88:91], v[48:51]
    v_mfma_f32_16x16x32_bf16 v[52:55], v[40:43], v[120:123], v[52:55]
    v_mfma_f32_16x16x32_bf16 v[48:51], v[44:47], v[92:95], v[48:51]
    v_mfma_f32_16x16x32_bf16 v[52:55], v[44:47], v[124:127], v[52:55]
    s_lshl_b32 s66, s64, 12
    s_add_u32 s66, s66, 0x830000
    s_lshl_b32 s27, s65, 9
    s_add_u32 s27, s27, s66
    s_mul_i32 s67, s64, 4352
    s_add_u32 s67, s67, 0x8ea800
    s_nop 1
    buffer_store_dword v48, v61, s[12:15], s27 offen sc1
    buffer_store_dword v52, v61, s[12:15], s27 offen offset:256 sc1
    s_lshl_b32 s99, s64, 16
    s_lshl_b32 s28, s65, 7
    s_add_u32 s99, s99, s28
    s_mov_b32 s8, s50
    s_mov_b32 s9, s51
    s_mov_b32 s10, 0x158000
    s_mov_b32 s11, 0x20000
    s_mov_b32 s29, 65536
L_std1:
    s_mov_b32 m0, s29
    s_add_u32 s29, s29, 1024
    buffer_load_dwordx4 v58, s[8:11], s99 offen lds
    s_add_u32 s99, s99, 8192
    s_cmp_lt_u32 s29, 69632
    s_cbranch_scc1 L_std1
    s_waitcnt vmcnt(0)
    s_mov_b64 exec, 1
    buffer_atomic_or v163, v56, s[12:15], s67 offen
    s_mov_b64 exec, -1
L_std2:
    s_mov_b32 m0, s29
    s_add_u32 s29, s29, 1024
    buffer_load_dwordx4 v58, s[8:11], s99 offen lds
    s_add_u32 s99, s99, 8192
    s_cmp_lt_u32 s29, 73728
    s_cbranch_scc1 L_std2
    s_waitcnt vmcnt(0)
    s_mov_b64 exec, 1
    s_mov_b32 s61, 0
L_pc:
    buffer_load_dword v2, v56, s[12:15], s67 offen sc1
    s_add_u32 s61, s61, 1
    s_cmp_gt_u32 s61, 131072
    s_cbranch_scc1 L_pc_x
    s_waitcnt vmcnt(0)
    s_setprio 3
    v_cmp_ne_u32 vcc, 0xff, v2
    s_setprio 0
    s_cbranch_vccz L_pc_x
    s_sleep 16
    s_branch L_pc
L_pc_x:
    s_waitcnt vmcnt(0)
    s_mov_b64 exec, -1
    buffer_load_dword v16, v61, s[12:15], s66 offen offset:0 sc1
    buffer_load_dword v17, v61, s[12:15], s66 offen offset:256 sc1
    buffer_load_dword v18, v61, s[12:15], s66 offen offset:512 sc1
    buffer_load_dword v19, v61, s[12:15], s66 offen offset:768 sc1
    buffer_load_dword v20, v61, s[12:15], s66 offen offset:1024 sc1
    buffer_load_dword v21, v61, s[12:15], s66 offen offset:1280 sc1
    buffer_load_dword v22, v61, s[12:15], s66 offen offset:1536 sc1
    buffer_load_dword v23, v61, s[12:15], s66 offen offset:1792 sc1
    buffer_load_dword v24, v61, s[12:15], s66 offen offset:2048 sc1
    buffer_load_dword v25, v61, s[12:15], s66 offen offset:2304 sc1
    buffer_load_dword v26, v61, s[12:15], s66 offen offset:2560 sc1
    buffer_load_dword v27, v61, s[12:15], s66 offen offset:2816 sc1
    buffer_load_dword v28, v61, s[12:15], s66 offen offset:3072 sc1
    buffer_load_dword v29, v61, s[12:15], s66 offen offset:3328 sc1
    buffer_load_dword v30, v61, s[12:15], s66 offen offset:3584 sc1
    buffer_load_dword v31, v61, s[12:15], s66 offen offset:3840 sc1
    s_add_u32 s33, s31, 8
L_woc:
    s_mov_b32 m0, s30
    s_lshl_b32 s32, s30, 3
    s_add_u32 s32, s32, s100
    buffer_load_dwordx4 v59, s[16:19], s32 offen offset:0 lds
    s_add_u32 s32, s32, 7168
    buffer_load_dwordx4 v59, s[16:19], s32 offen offset:1024 lds
    s_add_u32 s32, s32, 7168
    buffer_load_dwordx4 v59, s[16:19], s32 offen offset:2048 lds
    s_add_u32 s32, s32, 7168
    buffer_load_dwordx4 v59, s[16:19], s32 offen offset:3072 lds
    s_add_u32 s30, s30, 4096
    s_and_b32 s30, s30, 0xffff
    s_add_u32 s31, s31, 4
    s_cmp_lt_u32 s31, s33
    s_cbranch_scc1 L_woc
    ds_read_b64_tr_b16 v[64:65], v60 offset:0
    ds_read_b64_tr_b16 v[66:67], v60 offset:512
    ds_read_b64_tr_b16 v[68:69], v60 offset:32
    ds_read_b64_tr_b16 v[70:71], v60 offset:544
    ds_read_b64_tr_b16 v[72:73], v60 offset:64
    ds_read_b64_tr_b16 v[74:75], v60 offset:576
    ds_read_b64_tr_b16 v[76:77], v60 offset:96
    ds_read_b64_tr_b16 v[78:79], v60 offset:608
    ds_read_b64_tr_b16 v[80:81], v60 offset:4096
    ds_read_b64_tr_b16 v[82:83], v60 offset:4608
    ds_read_b64_tr_b16 v[84:85], v60 offset:4128
    ds_read_b64_tr_b16 v[86:87], v60 offset:4640
    ds_read_b64_tr_b16 v[88:89], v60 offset:4160
    ds_read_b64_tr_b16 v[90:91], v60 offset:4672
    s_waitcnt lgkmcnt(8)
    ds_read_b64_tr_b16 v[92:93], v60 offset:4192
    ds_read_b64_tr_b16 v[94:95], v60 offset:4704
    s_waitcnt lgkmcnt(0)
    s_cmp_eq_u32 s64, 21
    s_cselect_b32 exec_hi, 0, -1
    s_setprio 3
    s_waitcnt vmcnt(8)
    v_pk_add_f32 v[16:17], v[16:17], v[18:19]
    v_pk_add_f32 v[20:21], v[20:21], v[22:23]
    v_pk_add_f32 v[24:25], v[24:25], v[26:27]
    v_pk_add_f32 v[28:29], v[28:29], v[30:31]
    v_pk_add_f32 v[16:17], v[16:17], v[20:21]
    v_pk_add_f32 v[24:25], v[24:25], v[28:29]
    v_pk_add_f32 v[16:17], v[16:17], v[24:25]
    v_mul_f32 v2, 0xbfb8aa3b, v16
    v_exp_f32 v2, v2
    v_mul_f32 v16, v16, v17
    v_add_f32 v2, 1.0, v2
    v_rcp_f32 v2, v2
    s_nop 0
    v_mul_f32 v2, v2, v16
    v_cvt_pk_bf16_f32 v2, v2, v2
    ds_write_b16 v162, v2
    s_setprio 0
    s_mov_b64 exec, -1
    ds_read_b128 v[16:19], v10 offset:0
    ds_read_b128 v[20:23], v11 offset:0
    ds_read_b128 v[24:27], v12 offset:0
    ds_read_b128 v[28:31], v13 offset:0
    ds_read_b128 v[32:35], v10 offset:64
    ds_read_b128 v[36:39], v11 offset:64
    ds_read_b128 v[40:43], v12 offset:64
    ds_read_b128 v[44:47], v13 offset:64
    s_waitcnt lgkmcnt(0)
    v_mfma_f32_16x16x32_bf16 v[48:51], v[16:19], v[64:67], 0
    v_mfma_f32_16x16x32_bf16 v[48:51], v[20:23], v[68:71], v[48:51]
    v_mfma_f32_16x16x32_bf16 v[48:51], v[24:27], v[72:75], v[48:51]
    v_mfma_f32_16x16x32_bf16 v[48:51], v[28:31], v[76:79], v[48:51]
    v_mfma_f32_16x16x32_bf16 v[48:51], v[32:35], v[80:83], v[48:51]
    v_mfma_f32_16x16x32_bf16 v[48:51], v[36:39], v[84:87], v[48:51]
    v_mfma_f32_16x16x32_bf16 v[48:51], v[40:43], v[88:91], v[48:51]
    v_mfma_f32_16x16x32_bf16 v[48:51], v[44:47], v[92:95], v[48:51]
    s_mul_i32 s27, s65, 5632
    s_lshl_b32 s28, s64, 8
    s_add_u32 s27, s27, s28
    s_add_u32 s27, s27, 0x850000
    s_mul_i32 s67, s65, 4352
    s_add_u32 s67, s67, 0x904000
    s_nop 1
    buffer_store_dword v48, v61, s[12:15], s27 offen sc1
    s_add_u32 s33, s31, 8
L_wod:
    s_mov_b32 m0, s30
    s_lshl_b32 s32, s30, 3
    s_add_u32 s32, s32, s100
    buffer_load_dwordx4 v59, s[16:19], s32 offen offset:0 lds
    s_add_u32 s32, s32, 7168
    buffer_load_dwordx4 v59, s[16:19], s32 offen offset:1024 lds
    s_add_u32 s32, s32, 7168
    buffer_load_dwordx4 v59, s[16:19], s32 offen offset:2048 lds
    s_add_u32 s32, s32, 7168
    buffer_load_dwordx4 v59, s[16:19], s32 offen offset:3072 lds
    s_add_u32 s30, s30, 4096
    s_and_b32 s30, s30, 0xffff
    s_add_u32 s31, s31, 4
    s_cmp_lt_u32 s31, s33
    s_cbranch_scc1 L_wod
    s_waitcnt vmcnt(0)
    s_mov_b64 exec, 1
    buffer_atomic_or v164, v56, s[12:15], s67 offen
    s_mov_b64 exec, -1
L_worest:
    s_lshl_b32 s27, s22, 16
    s_lshl_b32 s28, s21, 12
    s_add_u32 s27, s27, s28
    s_add_u32 s27, s27, 0x600000
    s_add_u32 s28, s27, 32768
    buffer_store_dwordx4 v[152:155], v15, s[12:15], s27 offen offset:0 sc1
    buffer_store_dwordx4 v[152:155], v15, s[12:15], s27 offen offset:1024 sc1
    buffer_store_dwordx4 v[152:155], v15, s[12:15], s27 offen offset:2048 sc1
    buffer_store_dwordx4 v[152:155], v15, s[12:15], s27 offen offset:3072 sc1
    buffer_store_dwordx4 v[152:155], v15, s[12:15], s28 offen offset:0 sc1
    buffer_store_dwordx4 v[152:155], v15, s[12:15], s28 offen offset:1024 sc1
    buffer_store_dwordx4 v[152:155], v15, s[12:15], s28 offen offset:2048 sc1
    buffer_store_dwordx4 v[152:155], v15, s[12:15], s28 offen offset:3072 sc1
    s_lshl_b32 s27, s68, 8
    s_mov_b32 m0, 158464
    s_add_u32 s27, s27, 0x802000
    buffer_load_dword v61, s[12:15], s27 offen sc1 lds
    s_mov_b32 s33, 64
L_wor:
    s_mov_b32 m0, s30
    s_lshl_b32 s32, s30, 3
    s_add_u32 s32, s32, s100
    buffer_load_dwordx4 v59, s[16:19], s32 offen offset:0 lds
    s_add_u32 s32, s32, 7168
    s_waitcnt vmcnt(7)
    buffer_load_dwordx4 v59, s[16:19], s32 offen offset:1024 lds
    s_add_u32 s32, s32, 7168
    s_waitcnt vmcnt(7)
    buffer_load_dwordx4 v59, s[16:19], s32 offen offset:2048 lds
    s_add_u32 s32, s32, 7168
    s_waitcnt vmcnt(7)
    buffer_load_dwordx4 v59, s[16:19], s32 offen offset:3072 lds
    s_waitcnt vmcnt(7)
    s_add_u32 s30, s30, 4096
    s_and_b32 s30, s30, 0xffff
    s_add_u32 s31, s31, 4
    s_cmp_lt_u32 s31, s33
    s_cbranch_scc1 L_wor
    s_waitcnt vmcnt(0)
    s_lshr_b32 s27, s63, 6
    s_cmp_lg_u32 s27, s68
    s_cbranch_scc1 L_noy
    s_mul_i32 s67, s69, 4352
    s_add_u32 s67, s67, 0x904000
    s_mov_b64 exec, 1
    s_mov_b32 s61, 0
L_pm:
    buffer_load_dword v2, v56, s[12:15], s67 offen sc1
    s_add_u32 s61, s61, 1
    s_cmp_gt_u32 s61, 131072
    s_cbranch_scc1 L_pm_x
    s_waitcnt vmcnt(0)
    s_setprio 3
    v_cmp_ne_u32 vcc, 0x3fffff, v2
    s_setprio 0
    s_cbranch_vccz L_pm_x
    s_sleep 16
    s_branch L_pm
L_pm_x:
    s_waitcnt vmcnt(0)
    s_mov_b64 exec, -1
    s_mul_i32 s27, s69, 5632
    s_add_u32 s27, s27, 0x850000
    s_add_u32 s28, s27, 4096
    buffer_load_dword v16, v61, s[12:15], s27 offen offset:0 sc1
    buffer_load_dword v17, v61, s[12:15], s27 offen offset:256 sc1
    buffer_load_dword v18, v61, s[12:15], s27 offen offset:512 sc1
    buffer_load_dword v19, v61, s[12:15], s27 offen offset:768 sc1
    buffer_load_dword v20, v61, s[12:15], s27 offen offset:1024 sc1
    buffer_load_dword v21, v61, s[12:15], s27 offen offset:1280 sc1
    buffer_load_dword v22, v61, s[12:15], s27 offen offset:1536 sc1
    buffer_load_dword v23, v61, s[12:15], s27 offen offset:1792 sc1
    buffer_load_dword v24, v61, s[12:15], s27 offen offset:2048 sc1
    buffer_load_dword v25, v61, s[12:15], s27 offen offset:2304 sc1
    buffer_load_dword v26, v61, s[12:15], s27 offen offset:2560 sc1
    buffer_load_dword v27, v61, s[12:15], s27 offen offset:2816 sc1
    buffer_load_dword v28, v61, s[12:15], s27 offen offset:3072 sc1
    buffer_load_dword v29, v61, s[12:15], s27 offen offset:3328 sc1
    buffer_load_dword v30, v61, s[12:15], s27 offen offset:3584 sc1
    buffer_load_dword v31, v61, s[12:15], s27 offen offset:3840 sc1
    buffer_load_dword v32, v61, s[12:15], s28 offen offset:0 sc1
    buffer_load_dword v33, v61, s[12:15], s28 offen offset:256 sc1
    buffer_load_dword v34, v61, s[12:15], s28 offen offset:512 sc1
    buffer_load_dword v35, v61, s[12:15], s28 offen offset:768 sc1
    buffer_load_dword v36, v61, s[12:15], s28 offen offset:1024 sc1
    buffer_load_dword v37, v61, s[12:15], s28 offen offset:1280 sc1
    s_setprio 3
    s_waitcnt vmcnt(0)
    v_pk_add_f32 v[16:17], v[16:17], v[18:19]
    v_pk_add_f32 v[16:17], v[16:17], v[20:21]
    v_pk_add_f32 v[16:17], v[16:17], v[22:23]
    v_pk_add_f32 v[16:17], v[16:17], v[24:25]
    v_pk_add_f32 v[16:17], v[16:17], v[26:27]
    v_pk_add_f32 v[16:17], v[16:17], v[28:29]
    v_pk_add_f32 v[16:17], v[16:17], v[30:31]
    v_pk_add_f32 v[16:17], v[16:17], v[32:33]
    v_pk_add_f32 v[16:17], v[16:17], v[34:35]
    v_pk_add_f32 v[16:17], v[16:17], v[36:37]
    v_add_f32 v16, v16, v17
    ds_write_b32 v160, v16 offset:256
L_noy:
    s_setprio 3
    s_mul_i32 s26, s68, 4352
    s_add_u32 s26, s26, 0x8c8800
    s_mov_b64 exec, 1
    s_waitcnt lgkmcnt(0)
    s_mov_b32 s30, 0
    s_mov_b32 s61, 0
    s_barrier
    buffer_atomic_or v165, v56, s[12:15], s35 offen
    buffer_atomic_or v166, v56, s[12:15], s26 offen sc0
    s_sleep 5
L_qn0:
    buffer_atomic_or v156, v56, s[12:15], s26 offen sc0
    s_waitcnt vmcnt(1)
L_q0:
    v_readfirstlane_b32 s31, v166
    s_add_u32 s61, s61, 1
    s_and_b32 s31, s31, 0xff
    s_cmp_gt_u32 s61, 131072
    s_cselect_b32 s31, 0xff, s31
    s_bcnt1_i32_b32 s32, s31
    s_cmp_lt_u32 s32, 4
    s_cbranch_scc1 L_qc0
    s_cmp_lg_u32 s30, 0
    s_cbranch_scc1 L_qd0
    v_mov_b32 v2, s31
    s_mov_b32 s30, 1
    ds_write_b32 v161, v2 offset:20
    s_waitcnt lgkmcnt(0)
    s_barrier
L_qd0:
    s_cmp_eq_u32 s32, 8
    s_cbranch_scc1 L_qx
L_qc0:
L_qn1:
    buffer_atomic_or v166, v56, s[12:15], s26 offen sc0
    s_waitcnt vmcnt(1)
L_q1:
    v_readfirstlane_b32 s31, v156
    s_add_u32 s61, s61, 1
    s_and_b32 s31, s31, 0xff
    s_cmp_gt_u32 s61, 131072
    s_cselect_b32 s31, 0xff, s31
    s_bcnt1_i32_b32 s32, s31
    s_cmp_lt_u32 s32, 4
    s_cbranch_scc1 L_qc1
    s_cmp_lg_u32 s30, 0
    s_cbranch_scc1 L_qd1
    v_mov_b32 v2, s31
    s_mov_b32 s30, 1
    ds_write_b32 v161, v2 offset:20
    s_waitcnt lgkmcnt(0)
    s_barrier
L_qd1:
    s_cmp_eq_u32 s32, 8
    s_cbranch_scc1 L_qx
L_qc1:
    s_branch L_qn0
L_qx:
    s_barrier
    s_barrier
    buffer_atomic_or v165, v56, s[12:15], s35 offen offset:8
    s_barrier
    s_barrier
    s_barrier
L_end:
    s_endpgm
.section .rodata,"a"
.p2align 6
.amdhsa_kernel gated_mix__mha_block__moe_arch_mod__prompt_kernel
  .amdhsa_next_free_vgpr 168
  .amdhsa_next_free_sgpr 102
  .amdhsa_accum_offset 168
  .amdhsa_group_segment_fixed_size 0
  .amdhsa_kernarg_size 96
  .amdhsa_user_sgpr_count 2
  .amdhsa_user_sgpr_kernarg_segment_ptr 1
  .amdhsa_system_sgpr_workgroup_id_x 1
.end_amdhsa_kernel
```
